```python
import torch

def _softmax(x, axis=-1):
    return torch.softmax(x, dim=axis)
def _gelu(x):
    return torch.nn.functional.gelu(x, approximate="tanh")
def _silu(x):
    return torch.nn.functional.silu(x)
def _sigmoid(x):
    return torch.sigmoid(x)
def _layernorm(x, axis=-1, eps=1e-5):
    m = x.mean(dim=axis, keepdim=True)
    v = x.var(dim=axis, keepdim=True, unbiased=False)
    return (x - m) / torch.sqrt(v + eps)
def _scatter_add(tgt, idx, src, axis=0):
    return tgt.clone().index_add_(axis, idx, src)
def _segment_sum(src, seg, n):
    out = torch.zeros((n,) + src.shape[1:], dtype=src.dtype)
    return out.index_add_(0, seg, src)
def _pad(x, pw):
    flat = tuple(v for pair in reversed(pw) for v in pair)
    return torch.nn.functional.pad(x, flat)

kernel_name = 'parallel_sum__ssm_conv_s4d__dense_activation_gelu__prompt'

def setup_inputs():

    _w = (lambda a: (lambda t: t.to(torch.bfloat16) if t.is_floating_point() else t)(torch.as_tensor(a)))
    def _A_setup():
        Bsz, L, D, N = 1, 2048, 512, 128
        return {
            "u": _w((lambda *s: torch.randn(*s, dtype=torch.bfloat16) * 0.05)(Bsz, L, D)),
            "log_A_real": _w((lambda *s: torch.randn(*s, dtype=torch.bfloat16) * 12.8)(D, N) * 0.5),
            "A_imag": _w((lambda *s: torch.randn(*s, dtype=torch.bfloat16) * 0.05)(D, N) * 3.14),
            "C_real": _w((lambda *s: torch.randn(*s, dtype=torch.bfloat16) * 0.1)(D, N) / N ** 0.5),
            "C_imag": _w((lambda *s: torch.randn(*s, dtype=torch.bfloat16) * 0.2)(D, N) / N ** 0.5),
            "log_dt": _w((lambda *s: torch.randn(*s, dtype=torch.bfloat16) * 0.05)(D) * 0.5 - 4.0),
            "D_skip": _w((lambda *s: torch.randn(*s, dtype=torch.bfloat16) * 0.05)(D)),
        }
    _A_in = _A_setup()

    def _B_setup():
        B, S, D, F = 1, 2048, 512, 1792
        return {
            "x": _w((lambda *s: torch.randn(*s, dtype=torch.bfloat16) * 0.05)(B, S, D)),
            "w1": _w((lambda *s: torch.randn(*s, dtype=torch.bfloat16) * 0.8)(D, F) * (D ** -0.5)),
            "b1": _w((lambda *s: torch.randn(*s, dtype=torch.bfloat16) * 12.8)(F) * 0.01),
            "w2": _w((lambda *s: torch.randn(*s, dtype=torch.bfloat16) * 0.8)(F, D) * (F ** -0.5)),
            "b2": _w((lambda *s: torch.randn(*s, dtype=torch.bfloat16) * 12.8)(D) * 0.01),
        }
    _B_in = _B_setup()

    return {
        "A_u": _A_in["u"],
        "A_log_A_real": _A_in["log_A_real"],
        "A_A_imag": _A_in["A_imag"],
        "A_C_real": _A_in["C_real"],
        "A_C_imag": _A_in["C_imag"],
        "A_log_dt": _A_in["log_dt"],
        "A_D_skip": _A_in["D_skip"],
        "B_x": _B_in["x"],
        "B_w1": _B_in["w1"],
        "B_b1": _B_in["b1"],
        "B_w2": _B_in["w2"],
        "B_b2": _B_in["b2"],
    }

def reference(A_u, A_log_A_real, A_A_imag, A_C_real, A_C_imag, A_log_dt, A_D_skip, B_x, B_w1, B_b1, B_w2, B_b2):
    def _A_ref(u, log_A_real, A_imag, C_real, C_imag, log_dt, D_skip):
        L = u.shape[1]
        dt = torch.exp(log_dt)
        A = -torch.exp(log_A_real) + 1j * A_imag
        C = (C_real + 1j * C_imag) * dt[:, None]
        pos = (lambda x, dt: x.to(dt))(torch.arange(L), log_dt.dtype)
        P = torch.exp((A * dt[:, None])[:, :, None] * pos[None, None, :])
        K = 2.0 * torch.einsum("dn,dnl->dl", C, P).real
        L2 = 2 * L
        u_t = (lambda x, *d: x.permute(*d))(u, 0, 2, 1)
        Kf = (lambda x, *a, **k: torch.fft.rfft(x.float(), *a, **k))(K, L2)
        Uf = (lambda x, *a, **k: torch.fft.rfft(x.float(), *a, **k))(u_t, L2)
        y = (lambda x, *a, **k: torch.fft.irfft(x, *a, **k).to(torch.bfloat16))(Uf * Kf[None, :, :], L2)[:, :, :L]
        y = (lambda x, *d: x.permute(*d))(y, 0, 2, 1)
        return y + u * D_skip[None, None, :]

    def _B_ref(x, w1, b1, w2, b2):
        h = torch.einsum("bsd,df->bsf", x, w1) + b1
        h = _gelu(h)
        return torch.einsum("bsf,fd->bsd", h, w2) + b2

    x = A_u
    xn = _layernorm(x, axis=-1)
    return x + _A_ref(xn, A_log_A_real, A_A_imag, A_C_real, A_C_imag, A_log_dt, A_D_skip) + _B_ref(xn, B_w1, B_b1, B_w2, B_b2)
```

```asm
; @launch kernel=mid_kernel grid=(512,1,1) block=(256,1,1) lds=81920
.amdgcn_target "amdgcn-amd-amdhsa--gfx950"
.text
    .globl mid_kernel
    .p2align 8
    .type mid_kernel,@function
mid_kernel:
    s_load_dwordx2 s[4:5], s[0:1], 112
    s_memrealtime s[100:101]
    s_load_dwordx2 s[44:45], s[0:1], 0
    s_load_dwordx2 s[68:69], s[0:1], 104
    s_cmp_lt_u32 s2, 256
    s_cbranch_scc1 L_conv
    s_cmp_lt_u32 s2, 512
    s_cbranch_scc1 L_g1
    s_endpgm
L_g1:
    s_sub_u32 s3, s2, 256
    s_and_b32 s21, s3, 7
    s_lshr_b32 s20, s3, 3
    s_cmp_ge_u32 s20, 28
    s_cbranch_scc1 L_spare
    s_cmp_ge_u32 s20, 14
    s_cbranch_scc0 L_g1_lo
    s_sub_u32 s20, s20, 14
    s_add_u32 s21, s21, 8
L_g1_lo:
    s_load_dwordx2 s[6:7], s[0:1], 72
    s_load_dwordx2 s[48:49], s[0:1], 64
    s_waitcnt lgkmcnt(0)
    s_mov_b32 s8, s48
    s_mov_b32 s9, s49
    s_mov_b32 s10, 1835008
    s_mov_b32 s11, 0x00020000
    s_mov_b32 s12, s44
    s_mov_b32 s13, s45
    s_mov_b32 s14, 2097152
    s_mov_b32 s15, 0x00020000
    s_add_u32 s16, s4, 11010048
    s_addc_u32 s17, s5, 0
    s_mov_b32 s18, 7340032
    s_mov_b32 s19, 0x00020000
    s_mov_b32 s24, s6
    s_mov_b32 s25, s7
    s_mov_b32 s26, 3584
    s_mov_b32 s27, 0x00020000
    s_lshl_b32 s22, s20, 8
    s_lshl_b32 s23, s21, 17
    s_mov_b32 s47, 0xbdd2d3e8
    s_setprio 1
    s_mov_b32 s64, s4
    s_mov_b32 s65, s5
    s_mov_b32 s66, 196608
    s_mov_b32 s67, 0x00020000
    s_and_b32 s40, s2, 31
    s_lshl_b32 s40, s40, 12
    s_add_u32 s40, s40, 32768
    v_and_b32 v254, 31, v0
    v_lshl_add_u32 v254, v254, 7, s40
    v_mov_b32 v52, 0x3f803f80
    v_mov_b32 v53, 0x3f803f80
    v_mov_b32 v54, 0x3f803f80
    v_mov_b32 v55, 0x3f803f80
    v_mov_b32 v208, 0
    v_mov_b32 v209, 0
    v_mov_b32 v210, 0
    v_mov_b32 v211, 0
    v_mov_b32 v212, 0
    v_mov_b32 v213, 0
    v_mov_b32 v214, 0
    v_mov_b32 v215, 0
    v_mov_b32 v216, 0
    v_mov_b32 v217, 0
    v_mov_b32 v218, 0
    v_mov_b32 v219, 0
    v_mov_b32 v220, 0
    v_mov_b32 v221, 0
    v_mov_b32 v222, 0
    v_mov_b32 v223, 0
    v_mov_b32 v224, 0
    v_mov_b32 v225, 0
    v_mov_b32 v226, 0
    v_mov_b32 v227, 0
    v_mov_b32 v228, 0
    v_mov_b32 v229, 0
    v_mov_b32 v230, 0
    v_mov_b32 v231, 0
    v_mov_b32 v232, 0
    v_mov_b32 v233, 0
    v_mov_b32 v234, 0
    v_mov_b32 v235, 0
    v_mov_b32 v236, 0
    v_mov_b32 v237, 0
    v_mov_b32 v238, 0
    v_mov_b32 v239, 0
    v_and_b32 v12, 63, v0
    v_lshrrev_b32 v13, 6, v0
    v_and_b32 v14, 31, v12
    v_lshrrev_b32 v15, 5, v12
    v_readfirstlane_b32 s3, v13
    v_lshrrev_b32 v1, 2, v12
    v_lshl_add_u32 v1, v13, 4, v1
    v_and_b32 v2, 3, v12
    v_lshrrev_b32 v3, 2, v1
    v_and_b32 v3, 3, v3
    v_xor_b32 v2, v2, v3
    v_lshlrev_b32 v2, 4, v2
    s_mov_b32 s40, 1024
    v_mul_lo_u32 v3, v1, s40
    v_add3_u32 v22, v3, v2, s23
    v_add_u32 v23, 65536, v22
    v_lshrrev_b32 v1, 4, v12
    v_lshl_add_u32 v1, v13, 2, v1
    v_and_b32 v2, 15, v12
    v_lshrrev_b32 v3, 4, v12
    v_and_b32 v3, 3, v3
    v_lshlrev_b32 v3, 2, v3
    v_xor_b32 v2, v2, v3
    v_lshlrev_b32 v2, 4, v2
    s_mov_b32 s40, 3584
    v_mul_lo_u32 v3, v1, s40
    v_add3_u32 v20, v3, v2, s22
    v_add_u32 v21, 57344, v20
    s_lshl_b32 s46, s3, 10
    s_movk_i32 s41, 0
    s_mov_b32 s45, 0
    s_add_u32 m0, s46, 0
    s_nop 0
    buffer_load_dwordx4 v20, s[8:11], s45 offen lds
    s_add_u32 m0, s46, 4096
    s_nop 0
    buffer_load_dwordx4 v21, s[8:11], s45 offen lds
    s_add_u32 m0, s46, 8192
    s_nop 0
    buffer_load_dwordx4 v22, s[12:15], s41 offen lds
    s_add_u32 m0, s46, 12288
    s_nop 0
    buffer_load_dwordx4 v23, s[12:15], s41 offen lds
    v_lshrrev_b32 v3, 2, v14
    v_and_b32 v3, 3, v3
    v_mov_b32 v4, v15
    v_add_u32 v5, 2, v4
    v_and_b32 v8, 1, v13
    v_lshrrev_b32 v9, 1, v13
    v_lshl_add_u32 v6, v8, 6, v14
    v_lshlrev_b32 v6, 6, v6
    v_lshl_add_u32 v7, v9, 6, v14
    v_lshlrev_b32 v7, 6, v7
    v_add_u32 v7, 8192, v7
    v_xor_b32 v4, v4, v3
    v_xor_b32 v5, v5, v3
    v_lshl_add_u32 v28, v4, 4, v6
    v_lshl_add_u32 v29, v5, 4, v6
    v_lshl_add_u32 v30, v4, 4, v7
    v_lshl_add_u32 v31, v5, 4, v7
    v_and_b32 v3, 15, v12
    v_lshrrev_b32 v4, 2, v3
    v_lshl_add_u32 v4, v15, 3, v4
    v_lshlrev_b32 v4, 8, v4
    v_and_b32 v5, 1, v3
    v_lshl_add_u32 v4, v5, 3, v4
    v_and_b32 v5, 3, v3
    v_lshrrev_b32 v5, 1, v5
    v_lshrrev_b32 v6, 4, v12
    v_and_b32 v6, 1, v6
    v_lshl_add_u32 v5, v6, 1, v5
    v_and_b32 v9, 1, v13
    v_lshl_add_u32 v5, v9, 2, v5
    v_lshrrev_b32 v6, 2, v3
    v_lshlrev_b32 v6, 2, v6
    v_xor_b32 v7, v5, v6
    v_lshl_add_u32 v28, v7, 4, v4
    v_add_u32 v5, 8, v5
    v_xor_b32 v7, v5, v6
    v_lshl_add_u32 v29, v7, 4, v4
    v_add_u32 v32, 0x10000, v28
    v_add_u32 v33, 0x10000, v29
    v_add_u32 v34, 0x10000, v30
    v_add_u32 v35, 0x10000, v31
    v_mov_b32 v64, 0
    v_mov_b32 v65, 0
    v_mov_b32 v66, 0
    v_mov_b32 v67, 0
    v_mov_b32 v68, 0
    v_mov_b32 v69, 0
    v_mov_b32 v70, 0
    v_mov_b32 v71, 0
    v_mov_b32 v72, 0
    v_mov_b32 v73, 0
    v_mov_b32 v74, 0
    v_mov_b32 v75, 0
    v_mov_b32 v76, 0
    v_mov_b32 v77, 0
    v_mov_b32 v78, 0
    v_mov_b32 v79, 0
    v_mov_b32 v80, 0
    v_mov_b32 v81, 0
    v_mov_b32 v82, 0
    v_mov_b32 v83, 0
    v_mov_b32 v84, 0
    v_mov_b32 v85, 0
    v_mov_b32 v86, 0
    v_mov_b32 v87, 0
    v_mov_b32 v88, 0
    v_mov_b32 v89, 0
    v_mov_b32 v90, 0
    v_mov_b32 v91, 0
    v_mov_b32 v92, 0
    v_mov_b32 v93, 0
    v_mov_b32 v94, 0
    v_mov_b32 v95, 0
    v_mov_b32 v96, 0
    v_mov_b32 v97, 0
    v_mov_b32 v98, 0
    v_mov_b32 v99, 0
    v_mov_b32 v100, 0
    v_mov_b32 v101, 0
    v_mov_b32 v102, 0
    v_mov_b32 v103, 0
    v_mov_b32 v104, 0
    v_mov_b32 v105, 0
    v_mov_b32 v106, 0
    v_mov_b32 v107, 0
    v_mov_b32 v108, 0
    v_mov_b32 v109, 0
    v_mov_b32 v110, 0
    v_mov_b32 v111, 0
    v_mov_b32 v112, 0
    v_mov_b32 v113, 0
    v_mov_b32 v114, 0
    v_mov_b32 v115, 0
    v_mov_b32 v116, 0
    v_mov_b32 v117, 0
    v_mov_b32 v118, 0
    v_mov_b32 v119, 0
    v_mov_b32 v120, 0
    v_mov_b32 v121, 0
    v_mov_b32 v122, 0
    v_mov_b32 v123, 0
    v_mov_b32 v124, 0
    v_mov_b32 v125, 0
    v_mov_b32 v126, 0
    v_mov_b32 v127, 0
    s_waitcnt vmcnt(0)
    s_movk_i32 s41, 64
    s_mov_b32 s45, 114688
    s_add_u32 m0, s46, 16384
    s_nop 0
    buffer_load_dwordx4 v20, s[8:11], s45 offen lds
    s_add_u32 m0, s46, 20480
    s_nop 0
    buffer_load_dwordx4 v21, s[8:11], s45 offen lds
    s_add_u32 m0, s46, 24576
    s_nop 0
    buffer_load_dwordx4 v22, s[12:15], s41 offen lds
    s_add_u32 m0, s46, 28672
    s_nop 0
    buffer_load_dwordx4 v23, s[12:15], s41 offen lds
    s_movk_i32 s41, 128
    s_mov_b32 s45, 229376
    s_add_u32 m0, s46, 32768
    s_nop 0
    buffer_load_dwordx4 v20, s[8:11], s45 offen lds
    s_add_u32 m0, s46, 36864
    s_nop 0
    buffer_load_dwordx4 v21, s[8:11], s45 offen lds
    s_add_u32 m0, s46, 40960
    s_nop 0
    buffer_load_dwordx4 v22, s[12:15], s41 offen lds
    s_add_u32 m0, s46, 45056
    s_nop 0
    buffer_load_dwordx4 v23, s[12:15], s41 offen lds
    s_movk_i32 s41, 192
    s_mov_b32 s45, 344064
    s_add_u32 m0, s46, 49152
    s_nop 0
    buffer_load_dwordx4 v20, s[8:11], s45 offen lds
    s_add_u32 m0, s46, 53248
    s_nop 0
    buffer_load_dwordx4 v21, s[8:11], s45 offen lds
    s_add_u32 m0, s46, 57344
    s_nop 0
    buffer_load_dwordx4 v22, s[12:15], s41 offen lds
    s_add_u32 m0, s46, 61440
    s_nop 0
    buffer_load_dwordx4 v23, s[12:15], s41 offen lds
    s_movk_i32 s41, 256
    s_mov_b32 s45, 458752
    s_add_u32 m0, s46, 65536
    s_nop 0
    buffer_load_dwordx4 v20, s[8:11], s45 offen lds
    s_add_u32 m0, s46, 69632
    s_nop 0
    buffer_load_dwordx4 v21, s[8:11], s45 offen lds
    s_add_u32 m0, s46, 73728
    s_nop 0
    buffer_load_dwordx4 v22, s[12:15], s41 offen lds
    s_add_u32 m0, s46, 77824
    s_nop 0
    buffer_load_dwordx4 v23, s[12:15], s41 offen lds
    s_barrier
    ds_read_b64_tr_b16 v[128:129], v28 offset:0
    ds_read_b64_tr_b16 v[130:131], v28 offset:1024
    ds_read_b64_tr_b16 v[132:133], v29 offset:0
    ds_read_b64_tr_b16 v[134:135], v29 offset:1024
    ds_read_b128 v[136:139], v30 offset:0
    ds_read_b128 v[140:143], v30 offset:2048
    ds_read_b64_tr_b16 v[144:145], v28 offset:4096
    ds_read_b64_tr_b16 v[146:147], v28 offset:5120
    ds_read_b64_tr_b16 v[148:149], v29 offset:4096
    ds_read_b64_tr_b16 v[150:151], v29 offset:5120
    ds_read_b128 v[152:155], v31 offset:0
    ds_read_b128 v[156:159], v31 offset:2048
    s_waitcnt lgkmcnt(0)
    v_mfma_f32_32x32x16_bf16 v[64:79], v[128:131], v[136:139], v[64:79]
    s_waitcnt vmcnt(12)
    s_barrier
    ds_read_b64_tr_b16 v[160:161], v28 offset:16384
    ds_read_b64_tr_b16 v[162:163], v28 offset:17408
    ds_read_b64_tr_b16 v[164:165], v29 offset:16384
    v_mfma_f32_32x32x16_bf16 v[80:95], v[128:131], v[140:143], v[80:95]
    ds_read_b64_tr_b16 v[166:167], v29 offset:17408
    ds_read_b128 v[168:171], v30 offset:16384
    v_mfma_f32_32x32x16_bf16 v[208:223], v[128:131], v[52:55], v[208:223]
    ds_read_b128 v[172:175], v30 offset:18432
    ds_read_b64_tr_b16 v[176:177], v28 offset:20480
    v_mfma_f32_32x32x16_bf16 v[96:111], v[132:135], v[136:139], v[96:111]
    ds_read_b64_tr_b16 v[178:179], v28 offset:21504
    ds_read_b64_tr_b16 v[180:181], v29 offset:20480
    ds_read_b64_tr_b16 v[182:183], v29 offset:21504
    v_mfma_f32_32x32x16_bf16 v[112:127], v[132:135], v[140:143], v[112:127]
    ds_read_b128 v[184:187], v31 offset:16384
    ds_read_b128 v[188:191], v31 offset:18432
    v_mfma_f32_32x32x16_bf16 v[224:239], v[132:135], v[52:55], v[224:239]
    s_movk_i32 s41, 320
    s_mov_b32 s45, 573440
    s_add_u32 m0, s46, 0
    s_nop 0
    buffer_load_dwordx4 v20, s[8:11], s45 offen lds
    v_mfma_f32_32x32x16_bf16 v[64:79], v[144:147], v[152:155], v[64:79]
    s_add_u32 m0, s46, 4096
    s_nop 0
    buffer_load_dwordx4 v21, s[8:11], s45 offen lds
    v_mfma_f32_32x32x16_bf16 v[80:95], v[144:147], v[156:159], v[80:95]
    s_add_u32 m0, s46, 8192
    s_nop 0
    buffer_load_dwordx4 v22, s[12:15], s41 offen lds
    v_mfma_f32_32x32x16_bf16 v[208:223], v[144:147], v[52:55], v[208:223]
    s_add_u32 m0, s46, 12288
    s_nop 0
    buffer_load_dwordx4 v23, s[12:15], s41 offen lds
    v_mfma_f32_32x32x16_bf16 v[96:111], v[148:151], v[152:155], v[96:111]
    v_mfma_f32_32x32x16_bf16 v[112:127], v[148:151], v[156:159], v[112:127]
    v_mfma_f32_32x32x16_bf16 v[224:239], v[148:151], v[52:55], v[224:239]
    s_waitcnt lgkmcnt(0)
    v_mfma_f32_32x32x16_bf16 v[64:79], v[160:163], v[168:171], v[64:79]
    s_waitcnt vmcnt(12)
    s_barrier
    ds_read_b64_tr_b16 v[128:129], v28 offset:32768
    ds_read_b64_tr_b16 v[130:131], v28 offset:33792
    ds_read_b64_tr_b16 v[132:133], v29 offset:32768
    v_mfma_f32_32x32x16_bf16 v[80:95], v[160:163], v[172:175], v[80:95]
    ds_read_b64_tr_b16 v[134:135], v29 offset:33792
    ds_read_b128 v[136:139], v30 offset:32768
    v_mfma_f32_32x32x16_bf16 v[208:223], v[160:163], v[52:55], v[208:223]
    ds_read_b128 v[140:143], v30 offset:34816
    ds_read_b64_tr_b16 v[144:145], v28 offset:36864
    v_mfma_f32_32x32x16_bf16 v[96:111], v[164:167], v[168:171], v[96:111]
    ds_read_b64_tr_b16 v[146:147], v28 offset:37888
    ds_read_b64_tr_b16 v[148:149], v29 offset:36864
    ds_read_b64_tr_b16 v[150:151], v29 offset:37888
    v_mfma_f32_32x32x16_bf16 v[112:127], v[164:167], v[172:175], v[112:127]
    ds_read_b128 v[152:155], v31 offset:32768
    ds_read_b128 v[156:159], v31 offset:34816
    v_mfma_f32_32x32x16_bf16 v[224:239], v[164:167], v[52:55], v[224:239]
    s_movk_i32 s41, 384
    s_mov_b32 s45, 688128
    s_add_u32 m0, s46, 16384
    s_nop 0
    buffer_load_dwordx4 v20, s[8:11], s45 offen lds
    v_mfma_f32_32x32x16_bf16 v[64:79], v[176:179], v[184:187], v[64:79]
    s_add_u32 m0, s46, 20480
    s_nop 0
    buffer_load_dwordx4 v21, s[8:11], s45 offen lds
    v_mfma_f32_32x32x16_bf16 v[80:95], v[176:179], v[188:191], v[80:95]
    s_add_u32 m0, s46, 24576
    s_nop 0
    buffer_load_dwordx4 v22, s[12:15], s41 offen lds
    v_mfma_f32_32x32x16_bf16 v[208:223], v[176:179], v[52:55], v[208:223]
    s_add_u32 m0, s46, 28672
    s_nop 0
    buffer_load_dwordx4 v23, s[12:15], s41 offen lds
    v_mfma_f32_32x32x16_bf16 v[96:111], v[180:183], v[184:187], v[96:111]
    v_mfma_f32_32x32x16_bf16 v[112:127], v[180:183], v[188:191], v[112:127]
    v_mfma_f32_32x32x16_bf16 v[224:239], v[180:183], v[52:55], v[224:239]
    s_waitcnt lgkmcnt(0)
    v_mfma_f32_32x32x16_bf16 v[64:79], v[128:131], v[136:139], v[64:79]
    s_waitcnt vmcnt(12)
    s_barrier
    ds_read_b64_tr_b16 v[160:161], v28 offset:49152
    ds_read_b64_tr_b16 v[162:163], v28 offset:50176
    ds_read_b64_tr_b16 v[164:165], v29 offset:49152
    v_mfma_f32_32x32x16_bf16 v[80:95], v[128:131], v[140:143], v[80:95]
    ds_read_b64_tr_b16 v[166:167], v29 offset:50176
    ds_read_b128 v[168:171], v30 offset:49152
    v_mfma_f32_32x32x16_bf16 v[208:223], v[128:131], v[52:55], v[208:223]
    ds_read_b128 v[172:175], v30 offset:51200
    ds_read_b64_tr_b16 v[176:177], v28 offset:53248
    v_mfma_f32_32x32x16_bf16 v[96:111], v[132:135], v[136:139], v[96:111]
    ds_read_b64_tr_b16 v[178:179], v28 offset:54272
    ds_read_b64_tr_b16 v[180:181], v29 offset:53248
    ds_read_b64_tr_b16 v[182:183], v29 offset:54272
    v_mfma_f32_32x32x16_bf16 v[112:127], v[132:135], v[140:143], v[112:127]
    ds_read_b128 v[184:187], v31 offset:49152
    ds_read_b128 v[188:191], v31 offset:51200
    v_mfma_f32_32x32x16_bf16 v[224:239], v[132:135], v[52:55], v[224:239]
    s_movk_i32 s41, 448
    s_mov_b32 s45, 802816
    s_add_u32 m0, s46, 32768
    s_nop 0
    buffer_load_dwordx4 v20, s[8:11], s45 offen lds
    v_mfma_f32_32x32x16_bf16 v[64:79], v[144:147], v[152:155], v[64:79]
    s_add_u32 m0, s46, 36864
    s_nop 0
    buffer_load_dwordx4 v21, s[8:11], s45 offen lds
    v_mfma_f32_32x32x16_bf16 v[80:95], v[144:147], v[156:159], v[80:95]
    s_add_u32 m0, s46, 40960
    s_nop 0
    buffer_load_dwordx4 v22, s[12:15], s41 offen lds
    v_mfma_f32_32x32x16_bf16 v[208:223], v[144:147], v[52:55], v[208:223]
    s_add_u32 m0, s46, 45056
    s_nop 0
    buffer_load_dwordx4 v23, s[12:15], s41 offen lds
    v_mfma_f32_32x32x16_bf16 v[96:111], v[148:151], v[152:155], v[96:111]
    v_mfma_f32_32x32x16_bf16 v[112:127], v[148:151], v[156:159], v[112:127]
    v_mfma_f32_32x32x16_bf16 v[224:239], v[148:151], v[52:55], v[224:239]
    s_waitcnt lgkmcnt(0)
    v_mfma_f32_32x32x16_bf16 v[64:79], v[160:163], v[168:171], v[64:79]
    s_waitcnt vmcnt(12)
    s_barrier
    ds_read_b64_tr_b16 v[128:129], v32 offset:0
    ds_read_b64_tr_b16 v[130:131], v32 offset:1024
    ds_read_b64_tr_b16 v[132:133], v33 offset:0
    v_mfma_f32_32x32x16_bf16 v[80:95], v[160:163], v[172:175], v[80:95]
    ds_read_b64_tr_b16 v[134:135], v33 offset:1024
    ds_read_b128 v[136:139], v34 offset:0
    v_mfma_f32_32x32x16_bf16 v[208:223], v[160:163], v[52:55], v[208:223]
    ds_read_b128 v[140:143], v34 offset:2048
    ds_read_b64_tr_b16 v[144:145], v32 offset:4096
    v_mfma_f32_32x32x16_bf16 v[96:111], v[164:167], v[168:171], v[96:111]
    ds_read_b64_tr_b16 v[146:147], v32 offset:5120
    ds_read_b64_tr_b16 v[148:149], v33 offset:4096
    ds_read_b64_tr_b16 v[150:151], v33 offset:5120
    v_mfma_f32_32x32x16_bf16 v[112:127], v[164:167], v[172:175], v[112:127]
    ds_read_b128 v[152:155], v35 offset:0
    ds_read_b128 v[156:159], v35 offset:2048
    v_mfma_f32_32x32x16_bf16 v[224:239], v[164:167], v[52:55], v[224:239]
    s_movk_i32 s41, 512
    s_mov_b32 s45, 917504
    s_add_u32 m0, s46, 49152
    s_nop 0
    buffer_load_dwordx4 v20, s[8:11], s45 offen lds
    v_mfma_f32_32x32x16_bf16 v[64:79], v[176:179], v[184:187], v[64:79]
    s_add_u32 m0, s46, 53248
    s_nop 0
    buffer_load_dwordx4 v21, s[8:11], s45 offen lds
    v_mfma_f32_32x32x16_bf16 v[80:95], v[176:179], v[188:191], v[80:95]
    s_add_u32 m0, s46, 57344
    s_nop 0
    buffer_load_dwordx4 v22, s[12:15], s41 offen lds
    v_mfma_f32_32x32x16_bf16 v[208:223], v[176:179], v[52:55], v[208:223]
    s_add_u32 m0, s46, 61440
    s_nop 0
    buffer_load_dwordx4 v23, s[12:15], s41 offen lds
    v_mfma_f32_32x32x16_bf16 v[96:111], v[180:183], v[184:187], v[96:111]
    v_mfma_f32_32x32x16_bf16 v[112:127], v[180:183], v[188:191], v[112:127]
    v_mfma_f32_32x32x16_bf16 v[224:239], v[180:183], v[52:55], v[224:239]
    s_waitcnt lgkmcnt(0)
    v_mfma_f32_32x32x16_bf16 v[64:79], v[128:131], v[136:139], v[64:79]
    s_waitcnt vmcnt(12)
    s_barrier
    ds_read_b64_tr_b16 v[160:161], v28 offset:0
    ds_read_b64_tr_b16 v[162:163], v28 offset:1024
    ds_read_b64_tr_b16 v[164:165], v29 offset:0
    v_mfma_f32_32x32x16_bf16 v[80:95], v[128:131], v[140:143], v[80:95]
    ds_read_b64_tr_b16 v[166:167], v29 offset:1024
    ds_read_b128 v[168:171], v30 offset:0
    v_mfma_f32_32x32x16_bf16 v[208:223], v[128:131], v[52:55], v[208:223]
    ds_read_b128 v[172:175], v30 offset:2048
    ds_read_b64_tr_b16 v[176:177], v28 offset:4096
    v_mfma_f32_32x32x16_bf16 v[96:111], v[132:135], v[136:139], v[96:111]
    ds_read_b64_tr_b16 v[178:179], v28 offset:5120
    ds_read_b64_tr_b16 v[180:181], v29 offset:4096
    ds_read_b64_tr_b16 v[182:183], v29 offset:5120
    v_mfma_f32_32x32x16_bf16 v[112:127], v[132:135], v[140:143], v[112:127]
    ds_read_b128 v[184:187], v31 offset:0
    ds_read_b128 v[188:191], v31 offset:2048
    v_mfma_f32_32x32x16_bf16 v[224:239], v[132:135], v[52:55], v[224:239]
    s_movk_i32 s41, 576
    s_mov_b32 s45, 1032192
    s_add_u32 m0, s46, 65536
    s_nop 0
    buffer_load_dwordx4 v20, s[8:11], s45 offen lds
    v_mfma_f32_32x32x16_bf16 v[64:79], v[144:147], v[152:155], v[64:79]
    s_add_u32 m0, s46, 69632
    s_nop 0
    buffer_load_dwordx4 v21, s[8:11], s45 offen lds
    v_mfma_f32_32x32x16_bf16 v[80:95], v[144:147], v[156:159], v[80:95]
    s_add_u32 m0, s46, 73728
    s_nop 0
    buffer_load_dwordx4 v22, s[12:15], s41 offen lds
    v_mfma_f32_32x32x16_bf16 v[208:223], v[144:147], v[52:55], v[208:223]
    s_add_u32 m0, s46, 77824
    s_nop 0
    buffer_load_dwordx4 v23, s[12:15], s41 offen lds
    v_mfma_f32_32x32x16_bf16 v[96:111], v[148:151], v[152:155], v[96:111]
    v_mfma_f32_32x32x16_bf16 v[112:127], v[148:151], v[156:159], v[112:127]
    v_mfma_f32_32x32x16_bf16 v[224:239], v[148:151], v[52:55], v[224:239]
    s_waitcnt lgkmcnt(0)
    v_mfma_f32_32x32x16_bf16 v[64:79], v[160:163], v[168:171], v[64:79]
    s_waitcnt vmcnt(12)
    s_barrier
    ds_read_b64_tr_b16 v[128:129], v28 offset:16384
    ds_read_b64_tr_b16 v[130:131], v28 offset:17408
    ds_read_b64_tr_b16 v[132:133], v29 offset:16384
    v_mfma_f32_32x32x16_bf16 v[80:95], v[160:163], v[172:175], v[80:95]
    ds_read_b64_tr_b16 v[134:135], v29 offset:17408
    ds_read_b128 v[136:139], v30 offset:16384
    v_mfma_f32_32x32x16_bf16 v[208:223], v[160:163], v[52:55], v[208:223]
    ds_read_b128 v[140:143], v30 offset:18432
    ds_read_b64_tr_b16 v[144:145], v28 offset:20480
    v_mfma_f32_32x32x16_bf16 v[96:111], v[164:167], v[168:171], v[96:111]
    ds_read_b64_tr_b16 v[146:147], v28 offset:21504
    ds_read_b64_tr_b16 v[148:149], v29 offset:20480
    ds_read_b64_tr_b16 v[150:151], v29 offset:21504
    v_mfma_f32_32x32x16_bf16 v[112:127], v[164:167], v[172:175], v[112:127]
    ds_read_b128 v[152:155], v31 offset:16384
    ds_read_b128 v[156:159], v31 offset:18432
    v_mfma_f32_32x32x16_bf16 v[224:239], v[164:167], v[52:55], v[224:239]
    s_movk_i32 s41, 640
    s_mov_b32 s45, 1146880
    s_add_u32 m0, s46, 0
    s_nop 0
    buffer_load_dwordx4 v20, s[8:11], s45 offen lds
    v_mfma_f32_32x32x16_bf16 v[64:79], v[176:179], v[184:187], v[64:79]
    s_add_u32 m0, s46, 4096
    s_nop 0
    buffer_load_dwordx4 v21, s[8:11], s45 offen lds
    v_mfma_f32_32x32x16_bf16 v[80:95], v[176:179], v[188:191], v[80:95]
    s_add_u32 m0, s46, 8192
    s_nop 0
    buffer_load_dwordx4 v22, s[12:15], s41 offen lds
    v_mfma_f32_32x32x16_bf16 v[208:223], v[176:179], v[52:55], v[208:223]
    s_add_u32 m0, s46, 12288
    s_nop 0
    buffer_load_dwordx4 v23, s[12:15], s41 offen lds
    v_mfma_f32_32x32x16_bf16 v[96:111], v[180:183], v[184:187], v[96:111]
    v_mfma_f32_32x32x16_bf16 v[112:127], v[180:183], v[188:191], v[112:127]
    v_mfma_f32_32x32x16_bf16 v[224:239], v[180:183], v[52:55], v[224:239]
    s_waitcnt lgkmcnt(0)
    v_mfma_f32_32x32x16_bf16 v[64:79], v[128:131], v[136:139], v[64:79]
    s_waitcnt vmcnt(12)
    s_barrier
    ds_read_b64_tr_b16 v[160:161], v28 offset:32768
    ds_read_b64_tr_b16 v[162:163], v28 offset:33792
    ds_read_b64_tr_b16 v[164:165], v29 offset:32768
    v_mfma_f32_32x32x16_bf16 v[80:95], v[128:131], v[140:143], v[80:95]
    ds_read_b64_tr_b16 v[166:167], v29 offset:33792
    ds_read_b128 v[168:171], v30 offset:32768
    v_mfma_f32_32x32x16_bf16 v[208:223], v[128:131], v[52:55], v[208:223]
    ds_read_b128 v[172:175], v30 offset:34816
    ds_read_b64_tr_b16 v[176:177], v28 offset:36864
    v_mfma_f32_32x32x16_bf16 v[96:111], v[132:135], v[136:139], v[96:111]
    ds_read_b64_tr_b16 v[178:179], v28 offset:37888
    ds_read_b64_tr_b16 v[180:181], v29 offset:36864
    ds_read_b64_tr_b16 v[182:183], v29 offset:37888
    v_mfma_f32_32x32x16_bf16 v[112:127], v[132:135], v[140:143], v[112:127]
    ds_read_b128 v[184:187], v31 offset:32768
    ds_read_b128 v[188:191], v31 offset:34816
    v_mfma_f32_32x32x16_bf16 v[224:239], v[132:135], v[52:55], v[224:239]
    s_movk_i32 s41, 704
    s_mov_b32 s45, 1261568
    s_add_u32 m0, s46, 16384
    s_nop 0
    buffer_load_dwordx4 v20, s[8:11], s45 offen lds
    v_mfma_f32_32x32x16_bf16 v[64:79], v[144:147], v[152:155], v[64:79]
    s_add_u32 m0, s46, 20480
    s_nop 0
    buffer_load_dwordx4 v21, s[8:11], s45 offen lds
    v_mfma_f32_32x32x16_bf16 v[80:95], v[144:147], v[156:159], v[80:95]
    s_add_u32 m0, s46, 24576
    s_nop 0
    buffer_load_dwordx4 v22, s[12:15], s41 offen lds
    v_mfma_f32_32x32x16_bf16 v[208:223], v[144:147], v[52:55], v[208:223]
    s_add_u32 m0, s46, 28672
    s_nop 0
    buffer_load_dwordx4 v23, s[12:15], s41 offen lds
    v_mfma_f32_32x32x16_bf16 v[96:111], v[148:151], v[152:155], v[96:111]
    v_mfma_f32_32x32x16_bf16 v[112:127], v[148:151], v[156:159], v[112:127]
    v_mfma_f32_32x32x16_bf16 v[224:239], v[148:151], v[52:55], v[224:239]
    s_waitcnt lgkmcnt(0)
    v_mfma_f32_32x32x16_bf16 v[64:79], v[160:163], v[168:171], v[64:79]
    s_waitcnt vmcnt(12)
    s_barrier
    ds_read_b64_tr_b16 v[128:129], v28 offset:49152
    ds_read_b64_tr_b16 v[130:131], v28 offset:50176
    ds_read_b64_tr_b16 v[132:133], v29 offset:49152
    v_mfma_f32_32x32x16_bf16 v[80:95], v[160:163], v[172:175], v[80:95]
    ds_read_b64_tr_b16 v[134:135], v29 offset:50176
    ds_read_b128 v[136:139], v30 offset:49152
    v_mfma_f32_32x32x16_bf16 v[208:223], v[160:163], v[52:55], v[208:223]
    ds_read_b128 v[140:143], v30 offset:51200
    ds_read_b64_tr_b16 v[144:145], v28 offset:53248
    v_mfma_f32_32x32x16_bf16 v[96:111], v[164:167], v[168:171], v[96:111]
    ds_read_b64_tr_b16 v[146:147], v28 offset:54272
    ds_read_b64_tr_b16 v[148:149], v29 offset:53248
    ds_read_b64_tr_b16 v[150:151], v29 offset:54272
    v_mfma_f32_32x32x16_bf16 v[112:127], v[164:167], v[172:175], v[112:127]
    ds_read_b128 v[152:155], v31 offset:49152
    ds_read_b128 v[156:159], v31 offset:51200
    v_mfma_f32_32x32x16_bf16 v[224:239], v[164:167], v[52:55], v[224:239]
    s_movk_i32 s41, 768
    s_mov_b32 s45, 1376256
    s_add_u32 m0, s46, 32768
    s_nop 0
    buffer_load_dwordx4 v20, s[8:11], s45 offen lds
    v_mfma_f32_32x32x16_bf16 v[64:79], v[176:179], v[184:187], v[64:79]
    s_add_u32 m0, s46, 36864
    s_nop 0
    buffer_load_dwordx4 v21, s[8:11], s45 offen lds
    v_mfma_f32_32x32x16_bf16 v[80:95], v[176:179], v[188:191], v[80:95]
    s_add_u32 m0, s46, 40960
    s_nop 0
    buffer_load_dwordx4 v22, s[12:15], s41 offen lds
    v_mfma_f32_32x32x16_bf16 v[208:223], v[176:179], v[52:55], v[208:223]
    s_add_u32 m0, s46, 45056
    s_nop 0
    buffer_load_dwordx4 v23, s[12:15], s41 offen lds
    v_mfma_f32_32x32x16_bf16 v[96:111], v[180:183], v[184:187], v[96:111]
    v_mfma_f32_32x32x16_bf16 v[112:127], v[180:183], v[188:191], v[112:127]
    v_mfma_f32_32x32x16_bf16 v[224:239], v[180:183], v[52:55], v[224:239]
    s_waitcnt lgkmcnt(0)
    v_mfma_f32_32x32x16_bf16 v[64:79], v[128:131], v[136:139], v[64:79]
    s_waitcnt vmcnt(12)
    s_barrier
    ds_read_b64_tr_b16 v[160:161], v32 offset:0
    ds_read_b64_tr_b16 v[162:163], v32 offset:1024
    ds_read_b64_tr_b16 v[164:165], v33 offset:0
    v_mfma_f32_32x32x16_bf16 v[80:95], v[128:131], v[140:143], v[80:95]
    ds_read_b64_tr_b16 v[166:167], v33 offset:1024
    ds_read_b128 v[168:171], v34 offset:0
    v_mfma_f32_32x32x16_bf16 v[208:223], v[128:131], v[52:55], v[208:223]
    ds_read_b128 v[172:175], v34 offset:2048
    ds_read_b64_tr_b16 v[176:177], v32 offset:4096
    v_mfma_f32_32x32x16_bf16 v[96:111], v[132:135], v[136:139], v[96:111]
    ds_read_b64_tr_b16 v[178:179], v32 offset:5120
    ds_read_b64_tr_b16 v[180:181], v33 offset:4096
    ds_read_b64_tr_b16 v[182:183], v33 offset:5120
    v_mfma_f32_32x32x16_bf16 v[112:127], v[132:135], v[140:143], v[112:127]
    ds_read_b128 v[184:187], v35 offset:0
    ds_read_b128 v[188:191], v35 offset:2048
    v_mfma_f32_32x32x16_bf16 v[224:239], v[132:135], v[52:55], v[224:239]
    s_movk_i32 s41, 832
    s_mov_b32 s45, 1490944
    s_add_u32 m0, s46, 49152
    s_nop 0
    buffer_load_dwordx4 v20, s[8:11], s45 offen lds
    v_mfma_f32_32x32x16_bf16 v[64:79], v[144:147], v[152:155], v[64:79]
    s_add_u32 m0, s46, 53248
    s_nop 0
    buffer_load_dwordx4 v21, s[8:11], s45 offen lds
    v_mfma_f32_32x32x16_bf16 v[80:95], v[144:147], v[156:159], v[80:95]
    s_add_u32 m0, s46, 57344
    s_nop 0
    buffer_load_dwordx4 v22, s[12:15], s41 offen lds
    v_mfma_f32_32x32x16_bf16 v[208:223], v[144:147], v[52:55], v[208:223]
    s_add_u32 m0, s46, 61440
    s_nop 0
    buffer_load_dwordx4 v23, s[12:15], s41 offen lds
    v_mfma_f32_32x32x16_bf16 v[96:111], v[148:151], v[152:155], v[96:111]
    v_mfma_f32_32x32x16_bf16 v[112:127], v[148:151], v[156:159], v[112:127]
    v_mfma_f32_32x32x16_bf16 v[224:239], v[148:151], v[52:55], v[224:239]
    s_waitcnt lgkmcnt(0)
    v_mfma_f32_32x32x16_bf16 v[64:79], v[160:163], v[168:171], v[64:79]
    s_waitcnt vmcnt(12)
    s_barrier
    ds_read_b64_tr_b16 v[128:129], v28 offset:0
    ds_read_b64_tr_b16 v[130:131], v28 offset:1024
    ds_read_b64_tr_b16 v[132:133], v29 offset:0
    v_mfma_f32_32x32x16_bf16 v[80:95], v[160:163], v[172:175], v[80:95]
    ds_read_b64_tr_b16 v[134:135], v29 offset:1024
    ds_read_b128 v[136:139], v30 offset:0
    v_mfma_f32_32x32x16_bf16 v[208:223], v[160:163], v[52:55], v[208:223]
    ds_read_b128 v[140:143], v30 offset:2048
    ds_read_b64_tr_b16 v[144:145], v28 offset:4096
    v_mfma_f32_32x32x16_bf16 v[96:111], v[164:167], v[168:171], v[96:111]
    ds_read_b64_tr_b16 v[146:147], v28 offset:5120
    ds_read_b64_tr_b16 v[148:149], v29 offset:4096
    ds_read_b64_tr_b16 v[150:151], v29 offset:5120
    v_mfma_f32_32x32x16_bf16 v[112:127], v[164:167], v[172:175], v[112:127]
    ds_read_b128 v[152:155], v31 offset:0
    ds_read_b128 v[156:159], v31 offset:2048
    v_mfma_f32_32x32x16_bf16 v[224:239], v[164:167], v[52:55], v[224:239]
    s_movk_i32 s41, 896
    s_mov_b32 s45, 1605632
    s_add_u32 m0, s46, 65536
    s_nop 0
    buffer_load_dwordx4 v20, s[8:11], s45 offen lds
    v_mfma_f32_32x32x16_bf16 v[64:79], v[176:179], v[184:187], v[64:79]
    s_add_u32 m0, s46, 69632
    s_nop 0
    buffer_load_dwordx4 v21, s[8:11], s45 offen lds
    v_mfma_f32_32x32x16_bf16 v[80:95], v[176:179], v[188:191], v[80:95]
    s_add_u32 m0, s46, 73728
    s_nop 0
    buffer_load_dwordx4 v22, s[12:15], s41 offen lds
    v_mfma_f32_32x32x16_bf16 v[208:223], v[176:179], v[52:55], v[208:223]
    s_add_u32 m0, s46, 77824
    s_nop 0
    buffer_load_dwordx4 v23, s[12:15], s41 offen lds
    v_mfma_f32_32x32x16_bf16 v[96:111], v[180:183], v[184:187], v[96:111]
    v_mfma_f32_32x32x16_bf16 v[112:127], v[180:183], v[188:191], v[112:127]
    v_mfma_f32_32x32x16_bf16 v[224:239], v[180:183], v[52:55], v[224:239]
    s_waitcnt lgkmcnt(0)
    v_mfma_f32_32x32x16_bf16 v[64:79], v[128:131], v[136:139], v[64:79]
    s_waitcnt vmcnt(12)
    s_barrier
    s_cmp_lg_u32 s3, 0
    s_cbranch_scc1 L_pol_1
    buffer_load_dwordx2 v[250:251], v254, s[64:67], 0 offen sc0 sc1
L_pol_1:
    ds_read_b64_tr_b16 v[160:161], v28 offset:16384
    ds_read_b64_tr_b16 v[162:163], v28 offset:17408
    ds_read_b64_tr_b16 v[164:165], v29 offset:16384
    v_mfma_f32_32x32x16_bf16 v[80:95], v[128:131], v[140:143], v[80:95]
    ds_read_b64_tr_b16 v[166:167], v29 offset:17408
    ds_read_b128 v[168:171], v30 offset:16384
    v_mfma_f32_32x32x16_bf16 v[208:223], v[128:131], v[52:55], v[208:223]
    ds_read_b128 v[172:175], v30 offset:18432
    ds_read_b64_tr_b16 v[176:177], v28 offset:20480
    v_mfma_f32_32x32x16_bf16 v[96:111], v[132:135], v[136:139], v[96:111]
    ds_read_b64_tr_b16 v[178:179], v28 offset:21504
    ds_read_b64_tr_b16 v[180:181], v29 offset:20480
    ds_read_b64_tr_b16 v[182:183], v29 offset:21504
    v_mfma_f32_32x32x16_bf16 v[112:127], v[132:135], v[140:143], v[112:127]
    ds_read_b128 v[184:187], v31 offset:16384
    ds_read_b128 v[188:191], v31 offset:18432
    v_mfma_f32_32x32x16_bf16 v[224:239], v[132:135], v[52:55], v[224:239]
    s_movk_i32 s41, 960
    s_mov_b32 s45, 1720320
    s_add_u32 m0, s46, 0
    s_nop 0
    buffer_load_dwordx4 v20, s[8:11], s45 offen lds
    v_mfma_f32_32x32x16_bf16 v[64:79], v[144:147], v[152:155], v[64:79]
    s_add_u32 m0, s46, 4096
    s_nop 0
    buffer_load_dwordx4 v21, s[8:11], s45 offen lds
    v_mfma_f32_32x32x16_bf16 v[80:95], v[144:147], v[156:159], v[80:95]
    s_add_u32 m0, s46, 8192
    s_nop 0
    buffer_load_dwordx4 v22, s[12:15], s41 offen lds
    v_mfma_f32_32x32x16_bf16 v[208:223], v[144:147], v[52:55], v[208:223]
    s_add_u32 m0, s46, 12288
    s_nop 0
    buffer_load_dwordx4 v23, s[12:15], s41 offen lds
    v_and_b32 v36, 1, v13
    s_lshl_b32 s42, s20, 7
    v_lshl_add_u32 v37, v36, 5, s42
    v_lshl_add_u32 v37, v15, 2, v37
    v_lshlrev_b32 v37, 1, v37
    buffer_load_dwordx2 v[192:193], v37, s[24:27], 0 offen offset:0
    buffer_load_dwordx2 v[194:195], v37, s[24:27], 0 offen offset:16
    buffer_load_dwordx2 v[196:197], v37, s[24:27], 0 offen offset:32
    buffer_load_dwordx2 v[198:199], v37, s[24:27], 0 offen offset:48
    buffer_load_dwordx2 v[200:201], v37, s[24:27], 0 offen offset:128
    buffer_load_dwordx2 v[202:203], v37, s[24:27], 0 offen offset:144
    buffer_load_dwordx2 v[204:205], v37, s[24:27], 0 offen offset:160
    buffer_load_dwordx2 v[206:207], v37, s[24:27], 0 offen offset:176
    v_mfma_f32_32x32x16_bf16 v[96:111], v[148:151], v[152:155], v[96:111]
    v_mfma_f32_32x32x16_bf16 v[112:127], v[148:151], v[156:159], v[112:127]
    v_mfma_f32_32x32x16_bf16 v[224:239], v[148:151], v[52:55], v[224:239]
    s_waitcnt lgkmcnt(0)
    v_mfma_f32_32x32x16_bf16 v[64:79], v[160:163], v[168:171], v[64:79]
    s_waitcnt vmcnt(20)
    s_barrier
    ds_read_b64_tr_b16 v[128:129], v28 offset:32768
    ds_read_b64_tr_b16 v[130:131], v28 offset:33792
    ds_read_b64_tr_b16 v[132:133], v29 offset:32768
    v_mfma_f32_32x32x16_bf16 v[80:95], v[160:163], v[172:175], v[80:95]
    ds_read_b64_tr_b16 v[134:135], v29 offset:33792
    ds_read_b128 v[136:139], v30 offset:32768
    v_mfma_f32_32x32x16_bf16 v[208:223], v[160:163], v[52:55], v[208:223]
    ds_read_b128 v[140:143], v30 offset:34816
    ds_read_b64_tr_b16 v[144:145], v28 offset:36864
    v_mfma_f32_32x32x16_bf16 v[96:111], v[164:167], v[168:171], v[96:111]
    ds_read_b64_tr_b16 v[146:147], v28 offset:37888
    ds_read_b64_tr_b16 v[148:149], v29 offset:36864
    ds_read_b64_tr_b16 v[150:151], v29 offset:37888
    v_mfma_f32_32x32x16_bf16 v[112:127], v[164:167], v[172:175], v[112:127]
    ds_read_b128 v[152:155], v31 offset:32768
    ds_read_b128 v[156:159], v31 offset:34816
    v_mfma_f32_32x32x16_bf16 v[224:239], v[164:167], v[52:55], v[224:239]
    v_mfma_f32_32x32x16_bf16 v[64:79], v[176:179], v[184:187], v[64:79]
    v_mfma_f32_32x32x16_bf16 v[80:95], v[176:179], v[188:191], v[80:95]
    v_mfma_f32_32x32x16_bf16 v[208:223], v[176:179], v[52:55], v[208:223]
    v_mfma_f32_32x32x16_bf16 v[96:111], v[180:183], v[184:187], v[96:111]
    v_mfma_f32_32x32x16_bf16 v[112:127], v[180:183], v[188:191], v[112:127]
    v_mfma_f32_32x32x16_bf16 v[224:239], v[180:183], v[52:55], v[224:239]
    s_waitcnt lgkmcnt(0)
    v_mfma_f32_32x32x16_bf16 v[64:79], v[128:131], v[136:139], v[64:79]
    s_waitcnt vmcnt(16)
    s_barrier
    ds_read_b64_tr_b16 v[160:161], v28 offset:49152
    ds_read_b64_tr_b16 v[162:163], v28 offset:50176
    ds_read_b64_tr_b16 v[164:165], v29 offset:49152
    v_mfma_f32_32x32x16_bf16 v[80:95], v[128:131], v[140:143], v[80:95]
    ds_read_b64_tr_b16 v[166:167], v29 offset:50176
    ds_read_b128 v[168:171], v30 offset:49152
    v_mfma_f32_32x32x16_bf16 v[208:223], v[128:131], v[52:55], v[208:223]
    ds_read_b128 v[172:175], v30 offset:51200
    ds_read_b64_tr_b16 v[176:177], v28 offset:53248
    v_mfma_f32_32x32x16_bf16 v[96:111], v[132:135], v[136:139], v[96:111]
    ds_read_b64_tr_b16 v[178:179], v28 offset:54272
    ds_read_b64_tr_b16 v[180:181], v29 offset:53248
    ds_read_b64_tr_b16 v[182:183], v29 offset:54272
    v_mfma_f32_32x32x16_bf16 v[112:127], v[132:135], v[140:143], v[112:127]
    ds_read_b128 v[184:187], v31 offset:49152
    ds_read_b128 v[188:191], v31 offset:51200
    v_mfma_f32_32x32x16_bf16 v[224:239], v[132:135], v[52:55], v[224:239]
    v_mfma_f32_32x32x16_bf16 v[64:79], v[144:147], v[152:155], v[64:79]
    v_mfma_f32_32x32x16_bf16 v[80:95], v[144:147], v[156:159], v[80:95]
    v_mfma_f32_32x32x16_bf16 v[208:223], v[144:147], v[52:55], v[208:223]
    v_mfma_f32_32x32x16_bf16 v[96:111], v[148:151], v[152:155], v[96:111]
    v_mfma_f32_32x32x16_bf16 v[112:127], v[148:151], v[156:159], v[112:127]
    v_mfma_f32_32x32x16_bf16 v[224:239], v[148:151], v[52:55], v[224:239]
    s_waitcnt lgkmcnt(0)
    v_mfma_f32_32x32x16_bf16 v[64:79], v[160:163], v[168:171], v[64:79]
    s_waitcnt vmcnt(12)
    s_barrier
    s_cmp_lg_u32 s3, 0
    s_cbranch_scc1 L_g1ok_2
    s_memrealtime s[56:57]
    s_waitcnt lgkmcnt(0)
    s_add_u32 s56, s56, 128
    s_addc_u32 s57, s57, 0
    v_cmp_ge_u64 vcc, v[250:251], s[100:101]
    v_cmp_lt_u64 s[56:57], v[250:251], s[56:57]
    s_and_b64 s[56:57], s[56:57], vcc
    s_cmp_eq_u64 s[56:57], -1
    s_cbranch_scc1 L_g1ok_2
    s_mov_b32 s62, 0
L_spin_3:
    buffer_load_dwordx2 v[250:251], v254, s[64:67], 0 offen sc0 sc1
    s_waitcnt vmcnt(0)
    s_memrealtime s[56:57]
    s_waitcnt lgkmcnt(0)
    s_add_u32 s56, s56, 128
    s_addc_u32 s57, s57, 0
    v_cmp_ge_u64 vcc, v[250:251], s[100:101]
    v_cmp_lt_u64 s[56:57], v[250:251], s[56:57]
    s_and_b64 s[56:57], s[56:57], vcc
    s_cmp_eq_u64 s[56:57], -1
    s_cbranch_scc1 L_ok_4
    s_sleep 4
    s_add_u32 s62, s62, 1
    s_cmp_lt_u32 s62, 4000
    s_cbranch_scc1 L_spin_3
    s_lshl_b32 s60, s21, 7
    s_add_u32 s61, s60, 128
L_fb_5:
    v_and_b32 v129, 31, v0
    v_bfe_u32 v128, v0, 5, 1
    v_add_u32 v128, s60, v128
    v_lshlrev_b32 v130, 10, v128
    v_lshl_add_u32 v130, v129, 4, v130
    buffer_load_dwordx4 v[132:135], v130, s[12:15], 0 offen
    buffer_load_dwordx4 v[136:139], v130, s[12:15], 0 offen offset:512
    s_waitcnt vmcnt(0)
    v_lshlrev_b32 v140, 16, v132
    v_and_b32 v141, 0xffff0000, v132
    v_lshlrev_b32 v142, 16, v133
    v_and_b32 v143, 0xffff0000, v133
    v_lshlrev_b32 v144, 16, v134
    v_and_b32 v145, 0xffff0000, v134
    v_lshlrev_b32 v146, 16, v135
    v_and_b32 v147, 0xffff0000, v135
    v_lshlrev_b32 v148, 16, v136
    v_and_b32 v149, 0xffff0000, v136
    v_lshlrev_b32 v150, 16, v137
    v_and_b32 v151, 0xffff0000, v137
    v_lshlrev_b32 v152, 16, v138
    v_and_b32 v153, 0xffff0000, v138
    v_lshlrev_b32 v154, 16, v139
    v_and_b32 v155, 0xffff0000, v139
    v_add_f32 v156, v140, v141
    v_add_f32 v156, v156, v142
    v_add_f32 v156, v156, v143
    v_add_f32 v156, v156, v144
    v_add_f32 v156, v156, v145
    v_add_f32 v156, v156, v146
    v_add_f32 v156, v156, v147
    v_add_f32 v156, v156, v148
    v_add_f32 v156, v156, v149
    v_add_f32 v156, v156, v150
    v_add_f32 v156, v156, v151
    v_add_f32 v156, v156, v152
    v_add_f32 v156, v156, v153
    v_add_f32 v156, v156, v154
    v_add_f32 v156, v156, v155
    ds_swizzle_b32 v157, v156 offset:1055
    s_waitcnt lgkmcnt(0)
    v_add_f32 v156, v156, v157
    ds_swizzle_b32 v157, v156 offset:2079
    s_waitcnt lgkmcnt(0)
    v_add_f32 v156, v156, v157
    ds_swizzle_b32 v157, v156 offset:4127
    s_waitcnt lgkmcnt(0)
    v_add_f32 v156, v156, v157
    ds_swizzle_b32 v157, v156 offset:8223
    s_waitcnt lgkmcnt(0)
    v_add_f32 v156, v156, v157
    ds_swizzle_b32 v157, v156 offset:16415
    s_waitcnt lgkmcnt(0)
    v_add_f32 v156, v156, v157
    v_mul_f32 v156, 0x3b000000, v156
    v_sub_f32 v157, v140, v156
    v_mul_f32 v158, v157, v157
    v_sub_f32 v157, v141, v156
    v_fmac_f32 v158, v157, v157
    v_sub_f32 v157, v142, v156
    v_fmac_f32 v158, v157, v157
    v_sub_f32 v157, v143, v156
    v_fmac_f32 v158, v157, v157
    v_sub_f32 v157, v144, v156
    v_fmac_f32 v158, v157, v157
    v_sub_f32 v157, v145, v156
    v_fmac_f32 v158, v157, v157
    v_sub_f32 v157, v146, v156
    v_fmac_f32 v158, v157, v157
    v_sub_f32 v157, v147, v156
    v_fmac_f32 v158, v157, v157
    v_sub_f32 v157, v148, v156
    v_fmac_f32 v158, v157, v157
    v_sub_f32 v157, v149, v156
    v_fmac_f32 v158, v157, v157
    v_sub_f32 v157, v150, v156
    v_fmac_f32 v158, v157, v157
    v_sub_f32 v157, v151, v156
    v_fmac_f32 v158, v157, v157
    v_sub_f32 v157, v152, v156
    v_fmac_f32 v158, v157, v157
    v_sub_f32 v157, v153, v156
    v_fmac_f32 v158, v157, v157
    v_sub_f32 v157, v154, v156
    v_fmac_f32 v158, v157, v157
    v_sub_f32 v157, v155, v156
    v_fmac_f32 v158, v157, v157
    ds_swizzle_b32 v157, v158 offset:1055
    s_waitcnt lgkmcnt(0)
    v_add_f32 v158, v158, v157
    ds_swizzle_b32 v157, v158 offset:2079
    s_waitcnt lgkmcnt(0)
    v_add_f32 v158, v158, v157
    ds_swizzle_b32 v157, v158 offset:4127
    s_waitcnt lgkmcnt(0)
    v_add_f32 v158, v158, v157
    ds_swizzle_b32 v157, v158 offset:8223
    s_waitcnt lgkmcnt(0)
    v_add_f32 v158, v158, v157
    ds_swizzle_b32 v157, v158 offset:16415
    s_waitcnt lgkmcnt(0)
    v_add_f32 v158, v158, v157
    v_mul_f32 v158, 0x3b000000, v158
    v_cvt_pk_bf16_f32 v156, v156, v156
    v_lshlrev_b32 v156, 16, v156
    v_cvt_pk_bf16_f32 v158, v158, v158
    v_lshlrev_b32 v158, 16, v158
    v_add_f32 v158, 0x3727c5ac, v158
    v_cvt_pk_bf16_f32 v158, v158, v158
    v_lshlrev_b32 v158, 16, v158
    v_sqrt_f32 v158, v158
    s_nop 0
    v_cvt_pk_bf16_f32 v158, v158, v158
    v_lshlrev_b32 v158, 16, v158
    v_lshrrev_b32 v156, 16, v156
    v_or_b32 v156, v158, v156
    v_lshlrev_b32 v128, 2, v128
    v_cmp_eq_u32 vcc, 0, v129
    s_and_saveexec_b64 s[58:59], vcc
    buffer_store_dword v156, v128, s[64:67], 0 offen sc0 sc1
    s_mov_b64 exec, s[58:59]
    s_add_u32 s60, s60, 2
    s_cmp_lt_u32 s60, s61
    s_cbranch_scc1 L_fb_5
    s_waitcnt vmcnt(0)
L_ok_4:
L_g1ok_2:
    ds_read_b64_tr_b16 v[128:129], v32 offset:0
    ds_read_b64_tr_b16 v[130:131], v32 offset:1024
    ds_read_b64_tr_b16 v[132:133], v33 offset:0
    v_mfma_f32_32x32x16_bf16 v[80:95], v[160:163], v[172:175], v[80:95]
    ds_read_b64_tr_b16 v[134:135], v33 offset:1024
    ds_read_b128 v[136:139], v34 offset:0
    v_mfma_f32_32x32x16_bf16 v[208:223], v[160:163], v[52:55], v[208:223]
    ds_read_b128 v[140:143], v34 offset:2048
    ds_read_b64_tr_b16 v[144:145], v32 offset:4096
    v_mfma_f32_32x32x16_bf16 v[96:111], v[164:167], v[168:171], v[96:111]
    ds_read_b64_tr_b16 v[146:147], v32 offset:5120
    ds_read_b64_tr_b16 v[148:149], v33 offset:4096
    ds_read_b64_tr_b16 v[150:151], v33 offset:5120
    v_mfma_f32_32x32x16_bf16 v[112:127], v[164:167], v[172:175], v[112:127]
    ds_read_b128 v[152:155], v35 offset:0
    ds_read_b128 v[156:159], v35 offset:2048
    v_mfma_f32_32x32x16_bf16 v[224:239], v[164:167], v[52:55], v[224:239]
    v_mfma_f32_32x32x16_bf16 v[64:79], v[176:179], v[184:187], v[64:79]
    v_mfma_f32_32x32x16_bf16 v[80:95], v[176:179], v[188:191], v[80:95]
    v_mfma_f32_32x32x16_bf16 v[208:223], v[176:179], v[52:55], v[208:223]
    v_mfma_f32_32x32x16_bf16 v[96:111], v[180:183], v[184:187], v[96:111]
    v_mfma_f32_32x32x16_bf16 v[112:127], v[180:183], v[188:191], v[112:127]
    v_mfma_f32_32x32x16_bf16 v[224:239], v[180:183], v[52:55], v[224:239]
    s_waitcnt lgkmcnt(0)
    v_mfma_f32_32x32x16_bf16 v[64:79], v[128:131], v[136:139], v[64:79]
    s_waitcnt vmcnt(8)
    s_barrier
    v_lshrrev_b32 v39, 1, v13
    s_lshl_b32 s42, s21, 7
    v_lshl_add_u32 v39, v39, 6, s42
    v_add_u32 v39, v39, v14
    v_lshlrev_b32 v39, 2, v39
    buffer_load_dword v240, v39, s[64:67], 0 offen
    buffer_load_dword v241, v39, s[64:67], 0 offen offset:128
    ds_read_b64_tr_b16 v[160:161], v28 offset:0
    ds_read_b64_tr_b16 v[162:163], v28 offset:1024
    ds_read_b64_tr_b16 v[164:165], v29 offset:0
    v_mfma_f32_32x32x16_bf16 v[80:95], v[128:131], v[140:143], v[80:95]
    ds_read_b64_tr_b16 v[166:167], v29 offset:1024
    ds_read_b128 v[168:171], v30 offset:0
    v_mfma_f32_32x32x16_bf16 v[208:223], v[128:131], v[52:55], v[208:223]
    ds_read_b128 v[172:175], v30 offset:2048
    ds_read_b64_tr_b16 v[176:177], v28 offset:4096
    v_mfma_f32_32x32x16_bf16 v[96:111], v[132:135], v[136:139], v[96:111]
    ds_read_b64_tr_b16 v[178:179], v28 offset:5120
    ds_read_b64_tr_b16 v[180:181], v29 offset:4096
    ds_read_b64_tr_b16 v[182:183], v29 offset:5120
    v_mfma_f32_32x32x16_bf16 v[112:127], v[132:135], v[140:143], v[112:127]
    ds_read_b128 v[184:187], v31 offset:0
    ds_read_b128 v[188:191], v31 offset:2048
    v_mfma_f32_32x32x16_bf16 v[224:239], v[132:135], v[52:55], v[224:239]
    v_mfma_f32_32x32x16_bf16 v[64:79], v[144:147], v[152:155], v[64:79]
    v_mfma_f32_32x32x16_bf16 v[80:95], v[144:147], v[156:159], v[80:95]
    v_mfma_f32_32x32x16_bf16 v[208:223], v[144:147], v[52:55], v[208:223]
    v_mfma_f32_32x32x16_bf16 v[96:111], v[148:151], v[152:155], v[96:111]
    v_mfma_f32_32x32x16_bf16 v[112:127], v[148:151], v[156:159], v[112:127]
    v_mfma_f32_32x32x16_bf16 v[224:239], v[148:151], v[52:55], v[224:239]
    s_waitcnt lgkmcnt(0)
    v_mfma_f32_32x32x16_bf16 v[64:79], v[160:163], v[168:171], v[64:79]
    v_mfma_f32_32x32x16_bf16 v[80:95], v[160:163], v[172:175], v[80:95]
    v_mfma_f32_32x32x16_bf16 v[208:223], v[160:163], v[52:55], v[208:223]
    v_mfma_f32_32x32x16_bf16 v[96:111], v[164:167], v[168:171], v[96:111]
    v_mfma_f32_32x32x16_bf16 v[112:127], v[164:167], v[172:175], v[112:127]
    v_mfma_f32_32x32x16_bf16 v[224:239], v[164:167], v[52:55], v[224:239]
    v_mfma_f32_32x32x16_bf16 v[64:79], v[176:179], v[184:187], v[64:79]
    v_mfma_f32_32x32x16_bf16 v[80:95], v[176:179], v[188:191], v[80:95]
    v_mfma_f32_32x32x16_bf16 v[208:223], v[176:179], v[52:55], v[208:223]
    v_mfma_f32_32x32x16_bf16 v[96:111], v[180:183], v[184:187], v[96:111]
    v_mfma_f32_32x32x16_bf16 v[112:127], v[180:183], v[188:191], v[112:127]
    v_mfma_f32_32x32x16_bf16 v[224:239], v[180:183], v[52:55], v[224:239]
    s_nop 15
    s_nop 3
    v_lshrrev_b32 v19, 1, v13
    s_lshl_b32 s23, s21, 7
    v_lshl_add_u32 v22, v19, 6, s23
    v_add_u32 v22, v22, v14
    s_movk_i32 s40, 3584
    v_mul_lo_u32 v22, v22, s40
    v_add_u32 v22, v22, v37
    v_add_u32 v23, 114688, v22
    v_mov_b32 v44, 0xc0135761
    s_movk_i32 s41, 272
    v_mul_lo_u32 v45, v14, s41
    v_lshl_add_u32 v45, v15, 3, v45
    v_lshl_add_u32 v45, v36, 6, v45
    v_mul_u32_u24 v46, 17408, v19
    v_add_u32 v45, v45, v46
    v_lshrrev_b32 v46, 3, v12
    v_lshl_add_u32 v46, v13, 5, v46
    v_and_b32 v47, 7, v12
    v_mul_lo_u32 v48, v46, s41
    v_lshl_add_u32 v48, v47, 4, v48
    v_add_u32 v49, s23, v46
    s_movk_i32 s41, 3584
    v_mul_lo_u32 v49, v49, s41
    s_lshl_b32 s42, s20, 8
    v_lshl_add_u32 v50, v47, 4, s42
    v_add_u32 v49, v49, v50
    s_barrier
    s_load_dwordx2 s[6:7], s[0:1], 88
    s_load_dwordx2 s[48:49], s[0:1], 80
    s_load_dwordx2 s[50:51], s[0:1], 0
    s_load_dwordx2 s[52:53], s[0:1], 96
    s_load_dwordx2 s[70:71], s[68:69], 0
    s_waitcnt vmcnt(0) lgkmcnt(0)
L_tr_6:
    s_cmp_lg_u64 s[70:71], 0
    s_cbranch_scc1 L_tro_7
    v_mov_b32 v248, 0
    global_load_dwordx2 v[248:249], v248, s[68:69] sc0 sc1
    s_waitcnt vmcnt(0)
    v_readfirstlane_b32 s70, v248
    v_readfirstlane_b32 s71, v249
    s_branch L_tr_6
L_tro_7:
    s_memrealtime s[56:57]
    s_lshl_b32 s40, s21, 1
    s_lshr_b32 s41, s3, 1
    s_add_u32 s40, s40, s41
    s_lshl_b32 s40, s40, 9
    s_lshl_b32 s41, s20, 1
    s_and_b32 s42, s3, 1
    s_add_u32 s41, s41, s42
    s_lshl_b32 s41, s41, 3
    s_add_u32 s40, s40, s41
    s_add_u32 s76, s40, 180224
    s_mov_b32 s79, s20
    s_waitcnt lgkmcnt(0)
    v_mov_b32 v190, s56
    v_mov_b32 v191, s57
    v_mov_b32 v188, s56
    v_mov_b32 v189, s57
    v_and_b32 v242, 0xffff0000, v240
    v_rcp_f32 v242, v242
    v_lshlrev_b32 v240, 16, v240
    v_and_b32 v243, 0xffff0000, v241
    v_rcp_f32 v243, v243
    v_lshlrev_b32 v241, 16, v241
    s_nop 0
    v_lshlrev_b32 v24, 16, v192
    v_and_b32 v25, 0xffff0000, v192
    v_lshlrev_b32 v26, 16, v193
    v_and_b32 v27, 0xffff0000, v193
    v_fma_f32 v64, -v240, v208, v64
    v_fma_f32 v65, -v240, v209, v65
    v_fma_f32 v66, -v240, v210, v66
    v_fma_f32 v67, -v240, v211, v67
    v_fma_f32 v64, v64, v242, v24
    v_fma_f32 v65, v65, v242, v25
    v_fma_f32 v66, v66, v242, v26
    v_fma_f32 v67, v67, v242, v27
    v_mul_f32 v28, v64, v64
    v_mul_f32 v29, v65, v65
    v_mul_f32 v30, v66, v66
    v_mul_f32 v31, v67, v67
    v_fma_f32 v28, v28, s47, v44
    v_fma_f32 v29, v29, s47, v44
    v_fma_f32 v30, v30, s47, v44
    v_fma_f32 v31, v31, s47, v44
    v_mul_f32 v28, v28, v64
    v_mul_f32 v29, v29, v65
    v_mul_f32 v30, v30, v66
    v_mul_f32 v31, v31, v67
    v_exp_f32 v28, v28
    v_exp_f32 v29, v29
    v_exp_f32 v30, v30
    v_exp_f32 v31, v31
    v_add_f32 v28, 1.0, v28
    v_add_f32 v29, 1.0, v29
    v_add_f32 v30, 1.0, v30
    v_add_f32 v31, 1.0, v31
    v_rcp_f32 v28, v28
    v_rcp_f32 v29, v29
    v_rcp_f32 v30, v30
    v_rcp_f32 v31, v31
    v_mul_f32 v64, v64, v28
    v_mul_f32 v65, v65, v29
    v_mul_f32 v66, v66, v30
    v_mul_f32 v67, v67, v31
    v_cvt_pk_bf16_f32 v32, v64, v65
    v_cvt_pk_bf16_f32 v33, v66, v67
    ds_write_b64 v45, v[32:33] offset:0
    s_nop 1
    v_fma_f32 v80, -v241, v208, v80
    v_fma_f32 v81, -v241, v209, v81
    v_fma_f32 v82, -v241, v210, v82
    v_fma_f32 v83, -v241, v211, v83
    v_fma_f32 v80, v80, v243, v24
    v_fma_f32 v81, v81, v243, v25
    v_fma_f32 v82, v82, v243, v26
    v_fma_f32 v83, v83, v243, v27
    v_mul_f32 v28, v80, v80
    v_mul_f32 v29, v81, v81
    v_mul_f32 v30, v82, v82
    v_mul_f32 v31, v83, v83
    v_fma_f32 v28, v28, s47, v44
    v_fma_f32 v29, v29, s47, v44
    v_fma_f32 v30, v30, s47, v44
    v_fma_f32 v31, v31, s47, v44
    v_mul_f32 v28, v28, v80
    v_mul_f32 v29, v29, v81
    v_mul_f32 v30, v30, v82
    v_mul_f32 v31, v31, v83
    v_exp_f32 v28, v28
    v_exp_f32 v29, v29
    v_exp_f32 v30, v30
    v_exp_f32 v31, v31
    v_add_f32 v28, 1.0, v28
    v_add_f32 v29, 1.0, v29
    v_add_f32 v30, 1.0, v30
    v_add_f32 v31, 1.0, v31
    v_rcp_f32 v28, v28
    v_rcp_f32 v29, v29
    v_rcp_f32 v30, v30
    v_rcp_f32 v31, v31
    v_mul_f32 v80, v80, v28
    v_mul_f32 v81, v81, v29
    v_mul_f32 v82, v82, v30
    v_mul_f32 v83, v83, v31
    v_cvt_pk_bf16_f32 v32, v80, v81
    v_cvt_pk_bf16_f32 v33, v82, v83
    ds_write_b64 v45, v[32:33] offset:8704
    s_nop 1
    v_lshlrev_b32 v24, 16, v194
    v_and_b32 v25, 0xffff0000, v194
    v_lshlrev_b32 v26, 16, v195
    v_and_b32 v27, 0xffff0000, v195
    v_fma_f32 v68, -v240, v212, v68
    v_fma_f32 v69, -v240, v213, v69
    v_fma_f32 v70, -v240, v214, v70
    v_fma_f32 v71, -v240, v215, v71
    v_fma_f32 v68, v68, v242, v24
    v_fma_f32 v69, v69, v242, v25
    v_fma_f32 v70, v70, v242, v26
    v_fma_f32 v71, v71, v242, v27
    v_mul_f32 v28, v68, v68
    v_mul_f32 v29, v69, v69
    v_mul_f32 v30, v70, v70
    v_mul_f32 v31, v71, v71
    v_fma_f32 v28, v28, s47, v44
    v_fma_f32 v29, v29, s47, v44
    v_fma_f32 v30, v30, s47, v44
    v_fma_f32 v31, v31, s47, v44
    v_mul_f32 v28, v28, v68
    v_mul_f32 v29, v29, v69
    v_mul_f32 v30, v30, v70
    v_mul_f32 v31, v31, v71
    v_exp_f32 v28, v28
    v_exp_f32 v29, v29
    v_exp_f32 v30, v30
    v_exp_f32 v31, v31
    v_add_f32 v28, 1.0, v28
    v_add_f32 v29, 1.0, v29
    v_add_f32 v30, 1.0, v30
    v_add_f32 v31, 1.0, v31
    v_rcp_f32 v28, v28
    v_rcp_f32 v29, v29
    v_rcp_f32 v30, v30
    v_rcp_f32 v31, v31
    v_mul_f32 v68, v68, v28
    v_mul_f32 v69, v69, v29
    v_mul_f32 v70, v70, v30
    v_mul_f32 v71, v71, v31
    v_cvt_pk_bf16_f32 v32, v68, v69
    v_cvt_pk_bf16_f32 v33, v70, v71
    ds_write_b64 v45, v[32:33] offset:16
    s_nop 1
    v_fma_f32 v84, -v241, v212, v84
    v_fma_f32 v85, -v241, v213, v85
    v_fma_f32 v86, -v241, v214, v86
    v_fma_f32 v87, -v241, v215, v87
    v_fma_f32 v84, v84, v243, v24
    v_fma_f32 v85, v85, v243, v25
    v_fma_f32 v86, v86, v243, v26
    v_fma_f32 v87, v87, v243, v27
    v_mul_f32 v28, v84, v84
    v_mul_f32 v29, v85, v85
    v_mul_f32 v30, v86, v86
    v_mul_f32 v31, v87, v87
    v_fma_f32 v28, v28, s47, v44
    v_fma_f32 v29, v29, s47, v44
    v_fma_f32 v30, v30, s47, v44
    v_fma_f32 v31, v31, s47, v44
    v_mul_f32 v28, v28, v84
    v_mul_f32 v29, v29, v85
    v_mul_f32 v30, v30, v86
    v_mul_f32 v31, v31, v87
    v_exp_f32 v28, v28
    v_exp_f32 v29, v29
    v_exp_f32 v30, v30
    v_exp_f32 v31, v31
    v_add_f32 v28, 1.0, v28
    v_add_f32 v29, 1.0, v29
    v_add_f32 v30, 1.0, v30
    v_add_f32 v31, 1.0, v31
    v_rcp_f32 v28, v28
    v_rcp_f32 v29, v29
    v_rcp_f32 v30, v30
    v_rcp_f32 v31, v31
    v_mul_f32 v84, v84, v28
    v_mul_f32 v85, v85, v29
    v_mul_f32 v86, v86, v30
    v_mul_f32 v87, v87, v31
    v_cvt_pk_bf16_f32 v32, v84, v85
    v_cvt_pk_bf16_f32 v33, v86, v87
    ds_write_b64 v45, v[32:33] offset:8720
    s_nop 1
    v_lshlrev_b32 v24, 16, v196
    v_and_b32 v25, 0xffff0000, v196
    v_lshlrev_b32 v26, 16, v197
    v_and_b32 v27, 0xffff0000, v197
    v_fma_f32 v72, -v240, v216, v72
    v_fma_f32 v73, -v240, v217, v73
    v_fma_f32 v74, -v240, v218, v74
    v_fma_f32 v75, -v240, v219, v75
    v_fma_f32 v72, v72, v242, v24
    v_fma_f32 v73, v73, v242, v25
    v_fma_f32 v74, v74, v242, v26
    v_fma_f32 v75, v75, v242, v27
    v_mul_f32 v28, v72, v72
    v_mul_f32 v29, v73, v73
    v_mul_f32 v30, v74, v74
    v_mul_f32 v31, v75, v75
    v_fma_f32 v28, v28, s47, v44
    v_fma_f32 v29, v29, s47, v44
    v_fma_f32 v30, v30, s47, v44
    v_fma_f32 v31, v31, s47, v44
    v_mul_f32 v28, v28, v72
    v_mul_f32 v29, v29, v73
    v_mul_f32 v30, v30, v74
    v_mul_f32 v31, v31, v75
    v_exp_f32 v28, v28
    v_exp_f32 v29, v29
    v_exp_f32 v30, v30
    v_exp_f32 v31, v31
    v_add_f32 v28, 1.0, v28
    v_add_f32 v29, 1.0, v29
    v_add_f32 v30, 1.0, v30
    v_add_f32 v31, 1.0, v31
    v_rcp_f32 v28, v28
    v_rcp_f32 v29, v29
    v_rcp_f32 v30, v30
    v_rcp_f32 v31, v31
    v_mul_f32 v72, v72, v28
    v_mul_f32 v73, v73, v29
    v_mul_f32 v74, v74, v30
    v_mul_f32 v75, v75, v31
    v_cvt_pk_bf16_f32 v32, v72, v73
    v_cvt_pk_bf16_f32 v33, v74, v75
    ds_write_b64 v45, v[32:33] offset:32
    s_nop 1
    v_fma_f32 v88, -v241, v216, v88
    v_fma_f32 v89, -v241, v217, v89
    v_fma_f32 v90, -v241, v218, v90
    v_fma_f32 v91, -v241, v219, v91
    v_fma_f32 v88, v88, v243, v24
    v_fma_f32 v89, v89, v243, v25
    v_fma_f32 v90, v90, v243, v26
    v_fma_f32 v91, v91, v243, v27
    v_mul_f32 v28, v88, v88
    v_mul_f32 v29, v89, v89
    v_mul_f32 v30, v90, v90
    v_mul_f32 v31, v91, v91
    v_fma_f32 v28, v28, s47, v44
    v_fma_f32 v29, v29, s47, v44
    v_fma_f32 v30, v30, s47, v44
    v_fma_f32 v31, v31, s47, v44
    v_mul_f32 v28, v28, v88
    v_mul_f32 v29, v29, v89
    v_mul_f32 v30, v30, v90
    v_mul_f32 v31, v31, v91
    v_exp_f32 v28, v28
    v_exp_f32 v29, v29
    v_exp_f32 v30, v30
    v_exp_f32 v31, v31
    v_add_f32 v28, 1.0, v28
    v_add_f32 v29, 1.0, v29
    v_add_f32 v30, 1.0, v30
    v_add_f32 v31, 1.0, v31
    v_rcp_f32 v28, v28
    v_rcp_f32 v29, v29
    v_rcp_f32 v30, v30
    v_rcp_f32 v31, v31
    v_mul_f32 v88, v88, v28
    v_mul_f32 v89, v89, v29
    v_mul_f32 v90, v90, v30
    v_mul_f32 v91, v91, v31
    v_cvt_pk_bf16_f32 v32, v88, v89
    v_cvt_pk_bf16_f32 v33, v90, v91
    ds_write_b64 v45, v[32:33] offset:8736
    s_nop 1
    v_lshlrev_b32 v24, 16, v198
    v_and_b32 v25, 0xffff0000, v198
    v_lshlrev_b32 v26, 16, v199
    v_and_b32 v27, 0xffff0000, v199
    v_fma_f32 v76, -v240, v220, v76
    v_fma_f32 v77, -v240, v221, v77
    v_fma_f32 v78, -v240, v222, v78
    v_fma_f32 v79, -v240, v223, v79
    v_fma_f32 v76, v76, v242, v24
    v_fma_f32 v77, v77, v242, v25
    v_fma_f32 v78, v78, v242, v26
    v_fma_f32 v79, v79, v242, v27
    v_mul_f32 v28, v76, v76
    v_mul_f32 v29, v77, v77
    v_mul_f32 v30, v78, v78
    v_mul_f32 v31, v79, v79
    v_fma_f32 v28, v28, s47, v44
    v_fma_f32 v29, v29, s47, v44
    v_fma_f32 v30, v30, s47, v44
    v_fma_f32 v31, v31, s47, v44
    v_mul_f32 v28, v28, v76
    v_mul_f32 v29, v29, v77
    v_mul_f32 v30, v30, v78
    v_mul_f32 v31, v31, v79
    v_exp_f32 v28, v28
    v_exp_f32 v29, v29
    v_exp_f32 v30, v30
    v_exp_f32 v31, v31
    v_add_f32 v28, 1.0, v28
    v_add_f32 v29, 1.0, v29
    v_add_f32 v30, 1.0, v30
    v_add_f32 v31, 1.0, v31
    v_rcp_f32 v28, v28
    v_rcp_f32 v29, v29
    v_rcp_f32 v30, v30
    v_rcp_f32 v31, v31
    v_mul_f32 v76, v76, v28
    v_mul_f32 v77, v77, v29
    v_mul_f32 v78, v78, v30
    v_mul_f32 v79, v79, v31
    v_cvt_pk_bf16_f32 v32, v76, v77
    v_cvt_pk_bf16_f32 v33, v78, v79
    ds_write_b64 v45, v[32:33] offset:48
    s_nop 1
    v_fma_f32 v92, -v241, v220, v92
    v_fma_f32 v93, -v241, v221, v93
    v_fma_f32 v94, -v241, v222, v94
    v_fma_f32 v95, -v241, v223, v95
    v_fma_f32 v92, v92, v243, v24
    v_fma_f32 v93, v93, v243, v25
    v_fma_f32 v94, v94, v243, v26
    v_fma_f32 v95, v95, v243, v27
    v_mul_f32 v28, v92, v92
    v_mul_f32 v29, v93, v93
    v_mul_f32 v30, v94, v94
    v_mul_f32 v31, v95, v95
    v_fma_f32 v28, v28, s47, v44
    v_fma_f32 v29, v29, s47, v44
    v_fma_f32 v30, v30, s47, v44
    v_fma_f32 v31, v31, s47, v44
    v_mul_f32 v28, v28, v92
    v_mul_f32 v29, v29, v93
    v_mul_f32 v30, v30, v94
    v_mul_f32 v31, v31, v95
    v_exp_f32 v28, v28
    v_exp_f32 v29, v29
    v_exp_f32 v30, v30
    v_exp_f32 v31, v31
    v_add_f32 v28, 1.0, v28
    v_add_f32 v29, 1.0, v29
    v_add_f32 v30, 1.0, v30
    v_add_f32 v31, 1.0, v31
    v_rcp_f32 v28, v28
    v_rcp_f32 v29, v29
    v_rcp_f32 v30, v30
    v_rcp_f32 v31, v31
    v_mul_f32 v92, v92, v28
    v_mul_f32 v93, v93, v29
    v_mul_f32 v94, v94, v30
    v_mul_f32 v95, v95, v31
    v_cvt_pk_bf16_f32 v32, v92, v93
    v_cvt_pk_bf16_f32 v33, v94, v95
    ds_write_b64 v45, v[32:33] offset:8752
    s_nop 1
    v_lshlrev_b32 v24, 16, v200
    v_and_b32 v25, 0xffff0000, v200
    v_lshlrev_b32 v26, 16, v201
    v_and_b32 v27, 0xffff0000, v201
    v_fma_f32 v96, -v240, v224, v96
    v_fma_f32 v97, -v240, v225, v97
    v_fma_f32 v98, -v240, v226, v98
    v_fma_f32 v99, -v240, v227, v99
    v_fma_f32 v96, v96, v242, v24
    v_fma_f32 v97, v97, v242, v25
    v_fma_f32 v98, v98, v242, v26
    v_fma_f32 v99, v99, v242, v27
    v_mul_f32 v28, v96, v96
    v_mul_f32 v29, v97, v97
    v_mul_f32 v30, v98, v98
    v_mul_f32 v31, v99, v99
    v_fma_f32 v28, v28, s47, v44
    v_fma_f32 v29, v29, s47, v44
    v_fma_f32 v30, v30, s47, v44
    v_fma_f32 v31, v31, s47, v44
    v_mul_f32 v28, v28, v96
    v_mul_f32 v29, v29, v97
    v_mul_f32 v30, v30, v98
    v_mul_f32 v31, v31, v99
    v_exp_f32 v28, v28
    v_exp_f32 v29, v29
    v_exp_f32 v30, v30
    v_exp_f32 v31, v31
    v_add_f32 v28, 1.0, v28
    v_add_f32 v29, 1.0, v29
    v_add_f32 v30, 1.0, v30
    v_add_f32 v31, 1.0, v31
    v_rcp_f32 v28, v28
    v_rcp_f32 v29, v29
    v_rcp_f32 v30, v30
    v_rcp_f32 v31, v31
    v_mul_f32 v96, v96, v28
    v_mul_f32 v97, v97, v29
    v_mul_f32 v98, v98, v30
    v_mul_f32 v99, v99, v31
    v_cvt_pk_bf16_f32 v32, v96, v97
    v_cvt_pk_bf16_f32 v33, v98, v99
    ds_write_b64 v45, v[32:33] offset:128
    s_nop 1
    v_fma_f32 v112, -v241, v224, v112
    v_fma_f32 v113, -v241, v225, v113
    v_fma_f32 v114, -v241, v226, v114
    v_fma_f32 v115, -v241, v227, v115
    v_fma_f32 v112, v112, v243, v24
    v_fma_f32 v113, v113, v243, v25
    v_fma_f32 v114, v114, v243, v26
    v_fma_f32 v115, v115, v243, v27
    v_mul_f32 v28, v112, v112
    v_mul_f32 v29, v113, v113
    v_mul_f32 v30, v114, v114
    v_mul_f32 v31, v115, v115
    v_fma_f32 v28, v28, s47, v44
    v_fma_f32 v29, v29, s47, v44
    v_fma_f32 v30, v30, s47, v44
    v_fma_f32 v31, v31, s47, v44
    v_mul_f32 v28, v28, v112
    v_mul_f32 v29, v29, v113
    v_mul_f32 v30, v30, v114
    v_mul_f32 v31, v31, v115
    v_exp_f32 v28, v28
    v_exp_f32 v29, v29
    v_exp_f32 v30, v30
    v_exp_f32 v31, v31
    v_add_f32 v28, 1.0, v28
    v_add_f32 v29, 1.0, v29
    v_add_f32 v30, 1.0, v30
    v_add_f32 v31, 1.0, v31
    v_rcp_f32 v28, v28
    v_rcp_f32 v29, v29
    v_rcp_f32 v30, v30
    v_rcp_f32 v31, v31
    v_mul_f32 v112, v112, v28
    v_mul_f32 v113, v113, v29
    v_mul_f32 v114, v114, v30
    v_mul_f32 v115, v115, v31
    v_cvt_pk_bf16_f32 v32, v112, v113
    v_cvt_pk_bf16_f32 v33, v114, v115
    ds_write_b64 v45, v[32:33] offset:8832
    s_nop 1
    s_waitcnt lgkmcnt(2)
    s_barrier
    ds_read_b128 v[64:67], v48 offset:0
    ds_read_b128 v[68:71], v48 offset:2176
    ds_read_b128 v[72:75], v48 offset:4352
    ds_read_b128 v[76:79], v48 offset:6528
    v_lshlrev_b32 v24, 16, v202
    v_and_b32 v25, 0xffff0000, v202
    v_lshlrev_b32 v26, 16, v203
    v_and_b32 v27, 0xffff0000, v203
    v_fma_f32 v100, -v240, v228, v100
    v_fma_f32 v101, -v240, v229, v101
    v_fma_f32 v102, -v240, v230, v102
    v_fma_f32 v103, -v240, v231, v103
    v_fma_f32 v100, v100, v242, v24
    v_fma_f32 v101, v101, v242, v25
    v_fma_f32 v102, v102, v242, v26
    v_fma_f32 v103, v103, v242, v27
    v_mul_f32 v28, v100, v100
    v_mul_f32 v29, v101, v101
    v_mul_f32 v30, v102, v102
    v_mul_f32 v31, v103, v103
    v_fma_f32 v28, v28, s47, v44
    v_fma_f32 v29, v29, s47, v44
    v_fma_f32 v30, v30, s47, v44
    v_fma_f32 v31, v31, s47, v44
    v_mul_f32 v28, v28, v100
    v_mul_f32 v29, v29, v101
    v_mul_f32 v30, v30, v102
    v_mul_f32 v31, v31, v103
    v_exp_f32 v28, v28
    v_exp_f32 v29, v29
    v_exp_f32 v30, v30
    v_exp_f32 v31, v31
    v_add_f32 v28, 1.0, v28
    v_add_f32 v29, 1.0, v29
    v_add_f32 v30, 1.0, v30
    v_add_f32 v31, 1.0, v31
    v_rcp_f32 v28, v28
    v_rcp_f32 v29, v29
    v_rcp_f32 v30, v30
    v_rcp_f32 v31, v31
    v_mul_f32 v100, v100, v28
    v_mul_f32 v101, v101, v29
    v_mul_f32 v102, v102, v30
    v_mul_f32 v103, v103, v31
    v_cvt_pk_bf16_f32 v32, v100, v101
    v_cvt_pk_bf16_f32 v33, v102, v103
    ds_write_b64 v45, v[32:33] offset:144
    s_nop 1
    v_fma_f32 v116, -v241, v228, v116
    v_fma_f32 v117, -v241, v229, v117
    v_fma_f32 v118, -v241, v230, v118
    v_fma_f32 v119, -v241, v231, v119
    v_fma_f32 v116, v116, v243, v24
    v_fma_f32 v117, v117, v243, v25
    v_fma_f32 v118, v118, v243, v26
    v_fma_f32 v119, v119, v243, v27
    v_mul_f32 v28, v116, v116
    v_mul_f32 v29, v117, v117
    v_mul_f32 v30, v118, v118
    v_mul_f32 v31, v119, v119
    v_fma_f32 v28, v28, s47, v44
    v_fma_f32 v29, v29, s47, v44
    v_fma_f32 v30, v30, s47, v44
    v_fma_f32 v31, v31, s47, v44
    v_mul_f32 v28, v28, v116
    v_mul_f32 v29, v29, v117
    v_mul_f32 v30, v30, v118
    v_mul_f32 v31, v31, v119
    v_exp_f32 v28, v28
    v_exp_f32 v29, v29
    v_exp_f32 v30, v30
    v_exp_f32 v31, v31
    v_add_f32 v28, 1.0, v28
    v_add_f32 v29, 1.0, v29
    v_add_f32 v30, 1.0, v30
    v_add_f32 v31, 1.0, v31
    v_rcp_f32 v28, v28
    v_rcp_f32 v29, v29
    v_rcp_f32 v30, v30
    v_rcp_f32 v31, v31
    v_mul_f32 v116, v116, v28
    v_mul_f32 v117, v117, v29
    v_mul_f32 v118, v118, v30
    v_mul_f32 v119, v119, v31
    v_cvt_pk_bf16_f32 v32, v116, v117
    v_cvt_pk_bf16_f32 v33, v118, v119
    ds_write_b64 v45, v[32:33] offset:8848
    s_nop 1
    s_mov_b32 s40, 0
    s_waitcnt lgkmcnt(5)
    buffer_store_dwordx4 v[64:67], v49, s[16:19], s40 offen sc0 sc1
    s_mov_b32 s40, 28672
    s_waitcnt lgkmcnt(4)
    buffer_store_dwordx4 v[68:71], v49, s[16:19], s40 offen sc0 sc1
    s_mov_b32 s40, 57344
    s_waitcnt lgkmcnt(3)
    buffer_store_dwordx4 v[72:75], v49, s[16:19], s40 offen sc0 sc1
    s_mov_b32 s40, 86016
    s_waitcnt lgkmcnt(2)
    buffer_store_dwordx4 v[76:79], v49, s[16:19], s40 offen sc0 sc1
    v_lshlrev_b32 v24, 16, v204
    v_and_b32 v25, 0xffff0000, v204
    v_lshlrev_b32 v26, 16, v205
    v_and_b32 v27, 0xffff0000, v205
    v_fma_f32 v104, -v240, v232, v104
    v_fma_f32 v105, -v240, v233, v105
    v_fma_f32 v106, -v240, v234, v106
    v_fma_f32 v107, -v240, v235, v107
    v_fma_f32 v104, v104, v242, v24
    v_fma_f32 v105, v105, v242, v25
    v_fma_f32 v106, v106, v242, v26
    v_fma_f32 v107, v107, v242, v27
    v_mul_f32 v28, v104, v104
    v_mul_f32 v29, v105, v105
    v_mul_f32 v30, v106, v106
    v_mul_f32 v31, v107, v107
    v_fma_f32 v28, v28, s47, v44
    v_fma_f32 v29, v29, s47, v44
    v_fma_f32 v30, v30, s47, v44
    v_fma_f32 v31, v31, s47, v44
    v_mul_f32 v28, v28, v104
    v_mul_f32 v29, v29, v105
    v_mul_f32 v30, v30, v106
    v_mul_f32 v31, v31, v107
    v_exp_f32 v28, v28
    v_exp_f32 v29, v29
    v_exp_f32 v30, v30
    v_exp_f32 v31, v31
    v_add_f32 v28, 1.0, v28
    v_add_f32 v29, 1.0, v29
    v_add_f32 v30, 1.0, v30
    v_add_f32 v31, 1.0, v31
    v_rcp_f32 v28, v28
    v_rcp_f32 v29, v29
    v_rcp_f32 v30, v30
    v_rcp_f32 v31, v31
    v_mul_f32 v104, v104, v28
    v_mul_f32 v105, v105, v29
    v_mul_f32 v106, v106, v30
    v_mul_f32 v107, v107, v31
    v_cvt_pk_bf16_f32 v32, v104, v105
    v_cvt_pk_bf16_f32 v33, v106, v107
    ds_write_b64 v45, v[32:33] offset:160
    s_nop 1
    v_fma_f32 v120, -v241, v232, v120
    v_fma_f32 v121, -v241, v233, v121
    v_fma_f32 v122, -v241, v234, v122
    v_fma_f32 v123, -v241, v235, v123
    v_fma_f32 v120, v120, v243, v24
    v_fma_f32 v121, v121, v243, v25
    v_fma_f32 v122, v122, v243, v26
    v_fma_f32 v123, v123, v243, v27
    v_mul_f32 v28, v120, v120
    v_mul_f32 v29, v121, v121
    v_mul_f32 v30, v122, v122
    v_mul_f32 v31, v123, v123
    v_fma_f32 v28, v28, s47, v44
    v_fma_f32 v29, v29, s47, v44
    v_fma_f32 v30, v30, s47, v44
    v_fma_f32 v31, v31, s47, v44
    v_mul_f32 v28, v28, v120
    v_mul_f32 v29, v29, v121
    v_mul_f32 v30, v30, v122
    v_mul_f32 v31, v31, v123
    v_exp_f32 v28, v28
    v_exp_f32 v29, v29
    v_exp_f32 v30, v30
    v_exp_f32 v31, v31
    v_add_f32 v28, 1.0, v28
    v_add_f32 v29, 1.0, v29
    v_add_f32 v30, 1.0, v30
    v_add_f32 v31, 1.0, v31
    v_rcp_f32 v28, v28
    v_rcp_f32 v29, v29
    v_rcp_f32 v30, v30
    v_rcp_f32 v31, v31
    v_mul_f32 v120, v120, v28
    v_mul_f32 v121, v121, v29
    v_mul_f32 v122, v122, v30
    v_mul_f32 v123, v123, v31
    v_cvt_pk_bf16_f32 v32, v120, v121
    v_cvt_pk_bf16_f32 v33, v122, v123
    ds_write_b64 v45, v[32:33] offset:8864
    s_nop 1
    v_lshlrev_b32 v24, 16, v206
    v_and_b32 v25, 0xffff0000, v206
    v_lshlrev_b32 v26, 16, v207
    v_and_b32 v27, 0xffff0000, v207
    v_fma_f32 v108, -v240, v236, v108
    v_fma_f32 v109, -v240, v237, v109
    v_fma_f32 v110, -v240, v238, v110
    v_fma_f32 v111, -v240, v239, v111
    v_fma_f32 v108, v108, v242, v24
    v_fma_f32 v109, v109, v242, v25
    v_fma_f32 v110, v110, v242, v26
    v_fma_f32 v111, v111, v242, v27
    v_mul_f32 v28, v108, v108
    v_mul_f32 v29, v109, v109
    v_mul_f32 v30, v110, v110
    v_mul_f32 v31, v111, v111
    v_fma_f32 v28, v28, s47, v44
    v_fma_f32 v29, v29, s47, v44
    v_fma_f32 v30, v30, s47, v44
    v_fma_f32 v31, v31, s47, v44
    v_mul_f32 v28, v28, v108
    v_mul_f32 v29, v29, v109
    v_mul_f32 v30, v30, v110
    v_mul_f32 v31, v31, v111
    v_exp_f32 v28, v28
    v_exp_f32 v29, v29
    v_exp_f32 v30, v30
    v_exp_f32 v31, v31
    v_add_f32 v28, 1.0, v28
    v_add_f32 v29, 1.0, v29
    v_add_f32 v30, 1.0, v30
    v_add_f32 v31, 1.0, v31
    v_rcp_f32 v28, v28
    v_rcp_f32 v29, v29
    v_rcp_f32 v30, v30
    v_rcp_f32 v31, v31
    v_mul_f32 v108, v108, v28
    v_mul_f32 v109, v109, v29
    v_mul_f32 v110, v110, v30
    v_mul_f32 v111, v111, v31
    v_cvt_pk_bf16_f32 v32, v108, v109
    v_cvt_pk_bf16_f32 v33, v110, v111
    ds_write_b64 v45, v[32:33] offset:176
    s_nop 1
    v_fma_f32 v124, -v241, v236, v124
    v_fma_f32 v125, -v241, v237, v125
    v_fma_f32 v126, -v241, v238, v126
    v_fma_f32 v127, -v241, v239, v127
    v_fma_f32 v124, v124, v243, v24
    v_fma_f32 v125, v125, v243, v25
    v_fma_f32 v126, v126, v243, v26
    v_fma_f32 v127, v127, v243, v27
    v_mul_f32 v28, v124, v124
    v_mul_f32 v29, v125, v125
    v_mul_f32 v30, v126, v126
    v_mul_f32 v31, v127, v127
    v_fma_f32 v28, v28, s47, v44
    v_fma_f32 v29, v29, s47, v44
    v_fma_f32 v30, v30, s47, v44
    v_fma_f32 v31, v31, s47, v44
    v_mul_f32 v28, v28, v124
    v_mul_f32 v29, v29, v125
    v_mul_f32 v30, v30, v126
    v_mul_f32 v31, v31, v127
    v_exp_f32 v28, v28
    v_exp_f32 v29, v29
    v_exp_f32 v30, v30
    v_exp_f32 v31, v31
    v_add_f32 v28, 1.0, v28
    v_add_f32 v29, 1.0, v29
    v_add_f32 v30, 1.0, v30
    v_add_f32 v31, 1.0, v31
    v_rcp_f32 v28, v28
    v_rcp_f32 v29, v29
    v_rcp_f32 v30, v30
    v_rcp_f32 v31, v31
    v_mul_f32 v124, v124, v28
    v_mul_f32 v125, v125, v29
    v_mul_f32 v126, v126, v30
    v_mul_f32 v127, v127, v31
    v_cvt_pk_bf16_f32 v32, v124, v125
    v_cvt_pk_bf16_f32 v33, v126, v127
    ds_write_b64 v45, v[32:33] offset:8880
    s_nop 1
    s_waitcnt vmcnt(0)
    s_mov_b64 exec, 1
    buffer_store_dwordx2 v[190:191], off, s[64:67], s76 offset:0 sc0 sc1
    s_mov_b64 exec, -1
    s_waitcnt lgkmcnt(0)
    s_barrier
    s_cmp_eq_u32 s3, 1
    s_cbranch_scc1 L_py_8
    s_cmp_eq_u32 s3, 0
    s_cbranch_scc1 L_py_9
    ds_read_b128 v[64:67], v48 offset:128
    ds_read_b128 v[68:71], v48 offset:2304
    ds_read_b128 v[72:75], v48 offset:4480
    ds_read_b128 v[76:79], v48 offset:6656
    s_mov_b32 s40, 0
    s_waitcnt lgkmcnt(3)
    buffer_store_dwordx4 v[64:67], v49, s[16:19], s40 offen offset:128 sc0 sc1
    s_mov_b32 s40, 28672
    s_waitcnt lgkmcnt(2)
    buffer_store_dwordx4 v[68:71], v49, s[16:19], s40 offen offset:128 sc0 sc1
    s_mov_b32 s40, 57344
    s_waitcnt lgkmcnt(1)
    buffer_store_dwordx4 v[72:75], v49, s[16:19], s40 offen offset:128 sc0 sc1
    s_mov_b32 s40, 86016
    s_waitcnt lgkmcnt(0)
    buffer_store_dwordx4 v[76:79], v49, s[16:19], s40 offen offset:128 sc0 sc1
    s_branch L_py_10
L_py_9:
    ds_read_b128 v[64:67], v48 offset:128
    ds_read_b128 v[68:71], v48 offset:2304
    ds_read_b128 v[72:75], v48 offset:4480
    ds_read_b128 v[76:79], v48 offset:6656
    ds_read_b128 v[80:83], v48 offset:8832
    ds_read_b128 v[84:87], v48 offset:11008
    ds_read_b128 v[88:91], v48 offset:13184
    ds_read_b128 v[92:95], v48 offset:15360
    s_mov_b32 s40, 0
    s_waitcnt lgkmcnt(7)
    buffer_store_dwordx4 v[64:67], v49, s[16:19], s40 offen offset:128 sc0 sc1
    s_mov_b32 s40, 28672
    s_waitcnt lgkmcnt(6)
    buffer_store_dwordx4 v[68:71], v49, s[16:19], s40 offen offset:128 sc0 sc1
    s_mov_b32 s40, 57344
    s_waitcnt lgkmcnt(5)
    buffer_store_dwordx4 v[72:75], v49, s[16:19], s40 offen offset:128 sc0 sc1
    s_mov_b32 s40, 86016
    s_waitcnt lgkmcnt(4)
    buffer_store_dwordx4 v[76:79], v49, s[16:19], s40 offen offset:128 sc0 sc1
    s_mov_b32 s40, 114688
    s_waitcnt lgkmcnt(3)
    buffer_store_dwordx4 v[80:83], v49, s[16:19], s40 offen offset:128 sc0 sc1
    s_mov_b32 s40, 143360
    s_waitcnt lgkmcnt(2)
    buffer_store_dwordx4 v[84:87], v49, s[16:19], s40 offen offset:128 sc0 sc1
    s_mov_b32 s40, 172032
    s_waitcnt lgkmcnt(1)
    buffer_store_dwordx4 v[88:91], v49, s[16:19], s40 offen offset:128 sc0 sc1
    s_mov_b32 s40, 200704
    s_waitcnt lgkmcnt(0)
    buffer_store_dwordx4 v[92:95], v49, s[16:19], s40 offen offset:128 sc0 sc1
    s_branch L_py_10
L_py_8:
L_py_10:
    s_branch L_fin
L_end_mid:
    s_endpgm
L_spare:
    s_load_dwordx2 s[6:7], s[0:1], 80
    s_waitcnt lgkmcnt(0)
    s_mov_b32 s12, s44
    s_mov_b32 s13, s45
    s_mov_b32 s14, 2097152
    s_mov_b32 s15, 0x00020000
    v_lshrrev_b32 v1, 6, v0
    s_mov_b32 s64, s4
    s_mov_b32 s65, s5
    s_mov_b32 s66, 196608
    s_mov_b32 s67, 0x00020000
    s_and_b32 s40, s2, 31
    s_lshl_b32 s40, s40, 12
    s_add_u32 s40, s40, 32768
    v_and_b32 v254, 31, v0
    v_lshl_add_u32 v254, v254, 7, s40
    v_readfirstlane_b32 s62, v1
    s_setprio 3
    s_sub_u32 s61, s2, 480
    s_lshl_b32 s60, s61, 2
    s_add_u32 s60, s60, s62
    s_mov_b32 s3, s62
    s_add_u32 s72, s4, 2097152
    s_addc_u32 s73, s5, 0
    s_mov_b32 s74, 2097152
    s_mov_b32 s75, 0x00020000
    v_and_b32 v1, 63, v0
    v_lshlrev_b32 v55, 4, v1
    s_lshl_b32 s40, s60, 14
    s_mov_b32 s41, s40
    buffer_load_dwordx4 v[128:131], v55, s[12:15], s41 offen offset:0
    buffer_load_dwordx4 v[132:135], v55, s[12:15], s41 offen offset:1024
    buffer_load_dwordx4 v[136:139], v55, s[12:15], s41 offen offset:2048
    buffer_load_dwordx4 v[140:143], v55, s[12:15], s41 offen offset:3072
    s_add_u32 s41, s41, 4096
    buffer_load_dwordx4 v[144:147], v55, s[12:15], s41 offen offset:0
    buffer_load_dwordx4 v[148:151], v55, s[12:15], s41 offen offset:1024
    buffer_load_dwordx4 v[152:155], v55, s[12:15], s41 offen offset:2048
    buffer_load_dwordx4 v[156:159], v55, s[12:15], s41 offen offset:3072
    s_add_u32 s41, s41, 4096
    buffer_load_dwordx4 v[160:163], v55, s[12:15], s41 offen offset:0
    buffer_load_dwordx4 v[164:167], v55, s[12:15], s41 offen offset:1024
    buffer_load_dwordx4 v[168:171], v55, s[12:15], s41 offen offset:2048
    buffer_load_dwordx4 v[172:175], v55, s[12:15], s41 offen offset:3072
    s_add_u32 s41, s41, 4096
    buffer_load_dwordx4 v[176:179], v55, s[12:15], s41 offen offset:0
    buffer_load_dwordx4 v[180:183], v55, s[12:15], s41 offen offset:1024
    buffer_load_dwordx4 v[184:187], v55, s[12:15], s41 offen offset:2048
    buffer_load_dwordx4 v[188:191], v55, s[12:15], s41 offen offset:3072
    v_and_b32 v57, 3, v0
    v_bfe_u32 v56, v0, 2, 4
    v_lshlrev_b32 v58, 10, v56
    v_lshl_add_u32 v58, v57, 4, v58
    buffer_load_dwordx4 v[64:67], v58, s[12:15], s40 offen offset:0
    buffer_load_dwordx4 v[68:71], v58, s[12:15], s40 offen offset:64
    buffer_load_dwordx4 v[72:75], v58, s[12:15], s40 offen offset:128
    buffer_load_dwordx4 v[76:79], v58, s[12:15], s40 offen offset:192
    buffer_load_dwordx4 v[80:83], v58, s[12:15], s40 offen offset:256
    buffer_load_dwordx4 v[84:87], v58, s[12:15], s40 offen offset:320
    buffer_load_dwordx4 v[88:91], v58, s[12:15], s40 offen offset:384
    buffer_load_dwordx4 v[92:95], v58, s[12:15], s40 offen offset:448
    buffer_load_dwordx4 v[96:99], v58, s[12:15], s40 offen offset:512
    buffer_load_dwordx4 v[100:103], v58, s[12:15], s40 offen offset:576
    buffer_load_dwordx4 v[104:107], v58, s[12:15], s40 offen offset:640
    buffer_load_dwordx4 v[108:111], v58, s[12:15], s40 offen offset:704
    buffer_load_dwordx4 v[112:115], v58, s[12:15], s40 offen offset:768
    buffer_load_dwordx4 v[116:119], v58, s[12:15], s40 offen offset:832
    buffer_load_dwordx4 v[120:123], v58, s[12:15], s40 offen offset:896
    buffer_load_dwordx4 v[124:127], v58, s[12:15], s40 offen offset:960
    s_lshl_b32 s41, s60, 4
    v_add_u32 v56, s41, v56
    s_mul_i32 s41, s3, 17408
    s_movk_i32 s42, 272
    v_mul_lo_u32 v62, v1, s42
    v_add_u32 v62, s41, v62
    v_lshrrev_b32 v2, 4, v1
    v_mul_lo_u32 v63, v2, s42
    v_and_b32 v2, 15, v1
    v_lshl_add_u32 v63, v2, 4, v63
    v_add_u32 v63, s41, v63
    s_mov_b32 s42, 0x05040100
    s_mov_b32 s43, 0x07060302
    s_waitcnt vmcnt(16)
    v_perm_b32 v192, v132, v128, s42
    v_perm_b32 v193, v140, v136, s42
    v_perm_b32 v194, v148, v144, s42
    v_perm_b32 v195, v156, v152, s42
    v_perm_b32 v196, v164, v160, s42
    v_perm_b32 v197, v172, v168, s42
    v_perm_b32 v198, v180, v176, s42
    v_perm_b32 v199, v188, v184, s42
    ds_write_b128 v62, v[192:195] offset:0
    ds_write_b128 v62, v[196:199] offset:16
    v_perm_b32 v200, v132, v128, s43
    v_perm_b32 v201, v140, v136, s43
    v_perm_b32 v202, v148, v144, s43
    v_perm_b32 v203, v156, v152, s43
    v_perm_b32 v204, v164, v160, s43
    v_perm_b32 v205, v172, v168, s43
    v_perm_b32 v206, v180, v176, s43
    v_perm_b32 v207, v188, v184, s43
    ds_write_b128 v62, v[200:203] offset:32
    ds_write_b128 v62, v[204:207] offset:48
    v_perm_b32 v208, v133, v129, s42
    v_perm_b32 v209, v141, v137, s42
    v_perm_b32 v210, v149, v145, s42
    v_perm_b32 v211, v157, v153, s42
    v_perm_b32 v212, v165, v161, s42
    v_perm_b32 v213, v173, v169, s42
    v_perm_b32 v214, v181, v177, s42
    v_perm_b32 v215, v189, v185, s42
    ds_write_b128 v62, v[208:211] offset:64
    ds_write_b128 v62, v[212:215] offset:80
    v_perm_b32 v216, v133, v129, s43
    v_perm_b32 v217, v141, v137, s43
    v_perm_b32 v218, v149, v145, s43
    v_perm_b32 v219, v157, v153, s43
    v_perm_b32 v220, v165, v161, s43
    v_perm_b32 v221, v173, v169, s43
    v_perm_b32 v222, v181, v177, s43
    v_perm_b32 v223, v189, v185, s43
    ds_write_b128 v62, v[216:219] offset:96
    ds_write_b128 v62, v[220:223] offset:112
    v_perm_b32 v192, v134, v130, s42
    v_perm_b32 v193, v142, v138, s42
    v_perm_b32 v194, v150, v146, s42
    v_perm_b32 v195, v158, v154, s42
    v_perm_b32 v196, v166, v162, s42
    v_perm_b32 v197, v174, v170, s42
    v_perm_b32 v198, v182, v178, s42
    v_perm_b32 v199, v190, v186, s42
    ds_write_b128 v62, v[192:195] offset:128
    ds_write_b128 v62, v[196:199] offset:144
    v_perm_b32 v200, v134, v130, s43
    v_perm_b32 v201, v142, v138, s43
    v_perm_b32 v202, v150, v146, s43
    v_perm_b32 v203, v158, v154, s43
    v_perm_b32 v204, v166, v162, s43
    v_perm_b32 v205, v174, v170, s43
    v_perm_b32 v206, v182, v178, s43
    v_perm_b32 v207, v190, v186, s43
    ds_write_b128 v62, v[200:203] offset:160
    ds_write_b128 v62, v[204:207] offset:176
    v_perm_b32 v208, v135, v131, s42
    v_perm_b32 v209, v143, v139, s42
    v_perm_b32 v210, v151, v147, s42
    v_perm_b32 v211, v159, v155, s42
    v_perm_b32 v212, v167, v163, s42
    v_perm_b32 v213, v175, v171, s42
    v_perm_b32 v214, v183, v179, s42
    v_perm_b32 v215, v191, v187, s42
    ds_write_b128 v62, v[208:211] offset:192
    ds_write_b128 v62, v[212:215] offset:208
    v_perm_b32 v216, v135, v131, s43
    v_perm_b32 v217, v143, v139, s43
    v_perm_b32 v218, v151, v147, s43
    v_perm_b32 v219, v159, v155, s43
    v_perm_b32 v220, v167, v163, s43
    v_perm_b32 v221, v175, v171, s43
    v_perm_b32 v222, v183, v179, s43
    v_perm_b32 v223, v191, v187, s43
    ds_write_b128 v62, v[216:219] offset:224
    ds_write_b128 v62, v[220:223] offset:240
    s_waitcnt lgkmcnt(0)
    ds_read_b128 v[128:131], v63 offset:0
    ds_read_b128 v[132:135], v63 offset:1088
    ds_read_b128 v[136:139], v63 offset:2176
    ds_read_b128 v[140:143], v63 offset:3264
    ds_read_b128 v[144:147], v63 offset:4352
    ds_read_b128 v[148:151], v63 offset:5440
    ds_read_b128 v[152:155], v63 offset:6528
    ds_read_b128 v[156:159], v63 offset:7616
    ds_read_b128 v[160:163], v63 offset:8704
    ds_read_b128 v[164:167], v63 offset:9792
    ds_read_b128 v[168:171], v63 offset:10880
    ds_read_b128 v[172:175], v63 offset:11968
    ds_read_b128 v[176:179], v63 offset:13056
    ds_read_b128 v[180:183], v63 offset:14144
    ds_read_b128 v[184:187], v63 offset:15232
    ds_read_b128 v[188:191], v63 offset:16320
    s_mov_b32 s41, s40
    s_waitcnt lgkmcnt(15)
    buffer_store_dwordx4 v[128:131], v55, s[72:75], s41 offen offset:0 sc0 sc1
    s_waitcnt lgkmcnt(14)
    buffer_store_dwordx4 v[132:135], v55, s[72:75], s41 offen offset:1024 sc0 sc1
    s_waitcnt lgkmcnt(13)
    buffer_store_dwordx4 v[136:139], v55, s[72:75], s41 offen offset:2048 sc0 sc1
    s_waitcnt lgkmcnt(12)
    buffer_store_dwordx4 v[140:143], v55, s[72:75], s41 offen offset:3072 sc0 sc1
    s_add_u32 s41, s41, 4096
    s_waitcnt lgkmcnt(11)
    buffer_store_dwordx4 v[144:147], v55, s[72:75], s41 offen offset:0 sc0 sc1
    s_waitcnt lgkmcnt(10)
    buffer_store_dwordx4 v[148:151], v55, s[72:75], s41 offen offset:1024 sc0 sc1
    s_waitcnt lgkmcnt(9)
    buffer_store_dwordx4 v[152:155], v55, s[72:75], s41 offen offset:2048 sc0 sc1
    s_waitcnt lgkmcnt(8)
    buffer_store_dwordx4 v[156:159], v55, s[72:75], s41 offen offset:3072 sc0 sc1
    s_add_u32 s41, s41, 4096
    s_waitcnt lgkmcnt(7)
    buffer_store_dwordx4 v[160:163], v55, s[72:75], s41 offen offset:0 sc0 sc1
    s_waitcnt lgkmcnt(6)
    buffer_store_dwordx4 v[164:167], v55, s[72:75], s41 offen offset:1024 sc0 sc1
    s_waitcnt lgkmcnt(5)
    buffer_store_dwordx4 v[168:171], v55, s[72:75], s41 offen offset:2048 sc0 sc1
    s_waitcnt lgkmcnt(4)
    buffer_store_dwordx4 v[172:175], v55, s[72:75], s41 offen offset:3072 sc0 sc1
    s_add_u32 s41, s41, 4096
    s_waitcnt lgkmcnt(3)
    buffer_store_dwordx4 v[176:179], v55, s[72:75], s41 offen offset:0 sc0 sc1
    s_waitcnt lgkmcnt(2)
    buffer_store_dwordx4 v[180:183], v55, s[72:75], s41 offen offset:1024 sc0 sc1
    s_waitcnt lgkmcnt(1)
    buffer_store_dwordx4 v[184:187], v55, s[72:75], s41 offen offset:2048 sc0 sc1
    s_waitcnt lgkmcnt(0)
    buffer_store_dwordx4 v[188:191], v55, s[72:75], s41 offen offset:3072 sc0 sc1
    s_nop 4
    s_waitcnt vmcnt(31)
    v_lshlrev_b32 v128, 16, v64
    v_and_b32 v129, 0xffff0000, v64
    v_lshlrev_b32 v130, 16, v65
    v_and_b32 v131, 0xffff0000, v65
    v_lshlrev_b32 v132, 16, v66
    v_and_b32 v133, 0xffff0000, v66
    v_lshlrev_b32 v134, 16, v67
    v_and_b32 v135, 0xffff0000, v67
    v_mov_b32 v59, v128
    v_add_f32 v59, v59, v129
    v_add_f32 v59, v59, v130
    v_add_f32 v59, v59, v131
    v_mov_b32 v60, v132
    v_add_f32 v60, v60, v133
    v_add_f32 v60, v60, v134
    v_add_f32 v60, v60, v135
    s_waitcnt vmcnt(30)
    v_lshlrev_b32 v136, 16, v68
    v_and_b32 v137, 0xffff0000, v68
    v_lshlrev_b32 v138, 16, v69
    v_and_b32 v139, 0xffff0000, v69
    v_lshlrev_b32 v140, 16, v70
    v_and_b32 v141, 0xffff0000, v70
    v_lshlrev_b32 v142, 16, v71
    v_and_b32 v143, 0xffff0000, v71
    v_add_f32 v59, v59, v136
    v_add_f32 v59, v59, v137
    v_add_f32 v59, v59, v138
    v_add_f32 v59, v59, v139
    v_add_f32 v60, v60, v140
    v_add_f32 v60, v60, v141
    v_add_f32 v60, v60, v142
    v_add_f32 v60, v60, v143
    s_waitcnt vmcnt(29)
    v_lshlrev_b32 v144, 16, v72
    v_and_b32 v145, 0xffff0000, v72
    v_lshlrev_b32 v146, 16, v73
    v_and_b32 v147, 0xffff0000, v73
    v_lshlrev_b32 v148, 16, v74
    v_and_b32 v149, 0xffff0000, v74
    v_lshlrev_b32 v150, 16, v75
    v_and_b32 v151, 0xffff0000, v75
    v_add_f32 v59, v59, v144
    v_add_f32 v59, v59, v145
    v_add_f32 v59, v59, v146
    v_add_f32 v59, v59, v147
    v_add_f32 v60, v60, v148
    v_add_f32 v60, v60, v149
    v_add_f32 v60, v60, v150
    v_add_f32 v60, v60, v151
    s_waitcnt vmcnt(28)
    v_lshlrev_b32 v152, 16, v76
    v_and_b32 v153, 0xffff0000, v76
    v_lshlrev_b32 v154, 16, v77
    v_and_b32 v155, 0xffff0000, v77
    v_lshlrev_b32 v156, 16, v78
    v_and_b32 v157, 0xffff0000, v78
    v_lshlrev_b32 v158, 16, v79
    v_and_b32 v159, 0xffff0000, v79
    v_add_f32 v59, v59, v152
    v_add_f32 v59, v59, v153
    v_add_f32 v59, v59, v154
    v_add_f32 v59, v59, v155
    v_add_f32 v60, v60, v156
    v_add_f32 v60, v60, v157
    v_add_f32 v60, v60, v158
    v_add_f32 v60, v60, v159
    s_waitcnt vmcnt(27)
    v_lshlrev_b32 v160, 16, v80
    v_and_b32 v161, 0xffff0000, v80
    v_lshlrev_b32 v162, 16, v81
    v_and_b32 v163, 0xffff0000, v81
    v_lshlrev_b32 v164, 16, v82
    v_and_b32 v165, 0xffff0000, v82
    v_lshlrev_b32 v166, 16, v83
    v_and_b32 v167, 0xffff0000, v83
    v_add_f32 v59, v59, v160
    v_add_f32 v59, v59, v161
    v_add_f32 v59, v59, v162
    v_add_f32 v59, v59, v163
    v_add_f32 v60, v60, v164
    v_add_f32 v60, v60, v165
    v_add_f32 v60, v60, v166
    v_add_f32 v60, v60, v167
    s_waitcnt vmcnt(26)
    v_lshlrev_b32 v168, 16, v84
    v_and_b32 v169, 0xffff0000, v84
    v_lshlrev_b32 v170, 16, v85
    v_and_b32 v171, 0xffff0000, v85
    v_lshlrev_b32 v172, 16, v86
    v_and_b32 v173, 0xffff0000, v86
    v_lshlrev_b32 v174, 16, v87
    v_and_b32 v175, 0xffff0000, v87
    v_add_f32 v59, v59, v168
    v_add_f32 v59, v59, v169
    v_add_f32 v59, v59, v170
    v_add_f32 v59, v59, v171
    v_add_f32 v60, v60, v172
    v_add_f32 v60, v60, v173
    v_add_f32 v60, v60, v174
    v_add_f32 v60, v60, v175
    s_waitcnt vmcnt(25)
    v_lshlrev_b32 v176, 16, v88
    v_and_b32 v177, 0xffff0000, v88
    v_lshlrev_b32 v178, 16, v89
    v_and_b32 v179, 0xffff0000, v89
    v_lshlrev_b32 v180, 16, v90
    v_and_b32 v181, 0xffff0000, v90
    v_lshlrev_b32 v182, 16, v91
    v_and_b32 v183, 0xffff0000, v91
    v_add_f32 v59, v59, v176
    v_add_f32 v59, v59, v177
    v_add_f32 v59, v59, v178
    v_add_f32 v59, v59, v179
    v_add_f32 v60, v60, v180
    v_add_f32 v60, v60, v181
    v_add_f32 v60, v60, v182
    v_add_f32 v60, v60, v183
    s_waitcnt vmcnt(24)
    v_lshlrev_b32 v184, 16, v92
    v_and_b32 v185, 0xffff0000, v92
    v_lshlrev_b32 v186, 16, v93
    v_and_b32 v187, 0xffff0000, v93
    v_lshlrev_b32 v188, 16, v94
    v_and_b32 v189, 0xffff0000, v94
    v_lshlrev_b32 v190, 16, v95
    v_and_b32 v191, 0xffff0000, v95
    v_add_f32 v59, v59, v184
    v_add_f32 v59, v59, v185
    v_add_f32 v59, v59, v186
    v_add_f32 v59, v59, v187
    v_add_f32 v60, v60, v188
    v_add_f32 v60, v60, v189
    v_add_f32 v60, v60, v190
    v_add_f32 v60, v60, v191
    s_waitcnt vmcnt(23)
    v_lshlrev_b32 v192, 16, v96
    v_and_b32 v193, 0xffff0000, v96
    v_lshlrev_b32 v194, 16, v97
    v_and_b32 v195, 0xffff0000, v97
    v_lshlrev_b32 v196, 16, v98
    v_and_b32 v197, 0xffff0000, v98
    v_lshlrev_b32 v198, 16, v99
    v_and_b32 v199, 0xffff0000, v99
    v_add_f32 v59, v59, v192
    v_add_f32 v59, v59, v193
    v_add_f32 v59, v59, v194
    v_add_f32 v59, v59, v195
    v_add_f32 v60, v60, v196
    v_add_f32 v60, v60, v197
    v_add_f32 v60, v60, v198
    v_add_f32 v60, v60, v199
    s_waitcnt vmcnt(22)
    v_lshlrev_b32 v200, 16, v100
    v_and_b32 v201, 0xffff0000, v100
    v_lshlrev_b32 v202, 16, v101
    v_and_b32 v203, 0xffff0000, v101
    v_lshlrev_b32 v204, 16, v102
    v_and_b32 v205, 0xffff0000, v102
    v_lshlrev_b32 v206, 16, v103
    v_and_b32 v207, 0xffff0000, v103
    v_add_f32 v59, v59, v200
    v_add_f32 v59, v59, v201
    v_add_f32 v59, v59, v202
    v_add_f32 v59, v59, v203
    v_add_f32 v60, v60, v204
    v_add_f32 v60, v60, v205
    v_add_f32 v60, v60, v206
    v_add_f32 v60, v60, v207
    s_waitcnt vmcnt(21)
    v_lshlrev_b32 v208, 16, v104
    v_and_b32 v209, 0xffff0000, v104
    v_lshlrev_b32 v210, 16, v105
    v_and_b32 v211, 0xffff0000, v105
    v_lshlrev_b32 v212, 16, v106
    v_and_b32 v213, 0xffff0000, v106
    v_lshlrev_b32 v214, 16, v107
    v_and_b32 v215, 0xffff0000, v107
    v_add_f32 v59, v59, v208
    v_add_f32 v59, v59, v209
    v_add_f32 v59, v59, v210
    v_add_f32 v59, v59, v211
    v_add_f32 v60, v60, v212
    v_add_f32 v60, v60, v213
    v_add_f32 v60, v60, v214
    v_add_f32 v60, v60, v215
    s_waitcnt vmcnt(20)
    v_lshlrev_b32 v216, 16, v108
    v_and_b32 v217, 0xffff0000, v108
    v_lshlrev_b32 v218, 16, v109
    v_and_b32 v219, 0xffff0000, v109
    v_lshlrev_b32 v220, 16, v110
    v_and_b32 v221, 0xffff0000, v110
    v_lshlrev_b32 v222, 16, v111
    v_and_b32 v223, 0xffff0000, v111
    v_add_f32 v59, v59, v216
    v_add_f32 v59, v59, v217
    v_add_f32 v59, v59, v218
    v_add_f32 v59, v59, v219
    v_add_f32 v60, v60, v220
    v_add_f32 v60, v60, v221
    v_add_f32 v60, v60, v222
    v_add_f32 v60, v60, v223
    s_waitcnt vmcnt(19)
    v_lshlrev_b32 v224, 16, v112
    v_and_b32 v225, 0xffff0000, v112
    v_lshlrev_b32 v226, 16, v113
    v_and_b32 v227, 0xffff0000, v113
    v_lshlrev_b32 v228, 16, v114
    v_and_b32 v229, 0xffff0000, v114
    v_lshlrev_b32 v230, 16, v115
    v_and_b32 v231, 0xffff0000, v115
    v_add_f32 v59, v59, v224
    v_add_f32 v59, v59, v225
    v_add_f32 v59, v59, v226
    v_add_f32 v59, v59, v227
    v_add_f32 v60, v60, v228
    v_add_f32 v60, v60, v229
    v_add_f32 v60, v60, v230
    v_add_f32 v60, v60, v231
    s_waitcnt vmcnt(18)
    v_lshlrev_b32 v232, 16, v116
    v_and_b32 v233, 0xffff0000, v116
    v_lshlrev_b32 v234, 16, v117
    v_and_b32 v235, 0xffff0000, v117
    v_lshlrev_b32 v236, 16, v118
    v_and_b32 v237, 0xffff0000, v118
    v_lshlrev_b32 v238, 16, v119
    v_and_b32 v239, 0xffff0000, v119
    v_add_f32 v59, v59, v232
    v_add_f32 v59, v59, v233
    v_add_f32 v59, v59, v234
    v_add_f32 v59, v59, v235
    v_add_f32 v60, v60, v236
    v_add_f32 v60, v60, v237
    v_add_f32 v60, v60, v238
    v_add_f32 v60, v60, v239
    s_waitcnt vmcnt(17)
    v_lshlrev_b32 v240, 16, v120
    v_and_b32 v241, 0xffff0000, v120
    v_lshlrev_b32 v242, 16, v121
    v_and_b32 v243, 0xffff0000, v121
    v_lshlrev_b32 v244, 16, v122
    v_and_b32 v245, 0xffff0000, v122
    v_lshlrev_b32 v246, 16, v123
    v_and_b32 v247, 0xffff0000, v123
    v_add_f32 v59, v59, v240
    v_add_f32 v59, v59, v241
    v_add_f32 v59, v59, v242
    v_add_f32 v59, v59, v243
    v_add_f32 v60, v60, v244
    v_add_f32 v60, v60, v245
    v_add_f32 v60, v60, v246
    v_add_f32 v60, v60, v247
    s_waitcnt vmcnt(16)
    v_lshlrev_b32 v248, 16, v124
    v_and_b32 v249, 0xffff0000, v124
    v_lshlrev_b32 v250, 16, v125
    v_and_b32 v251, 0xffff0000, v125
    v_lshlrev_b32 v252, 16, v126
    v_and_b32 v253, 0xffff0000, v126
    v_lshlrev_b32 v254, 16, v127
    v_and_b32 v255, 0xffff0000, v127
    v_add_f32 v59, v59, v248
    v_add_f32 v59, v59, v249
    v_add_f32 v59, v59, v250
    v_add_f32 v59, v59, v251
    v_add_f32 v60, v60, v252
    v_add_f32 v60, v60, v253
    v_add_f32 v60, v60, v254
    v_add_f32 v60, v60, v255
    v_add_f32 v59, v59, v60
    ds_swizzle_b32 v61, v59 offset:1055
    s_waitcnt lgkmcnt(0)
    v_add_f32 v59, v59, v61
    ds_swizzle_b32 v61, v59 offset:2079
    s_waitcnt lgkmcnt(0)
    v_add_f32 v59, v59, v61
    v_mul_f32 v59, 0x3b000000, v59
    v_sub_f32 v128, v128, v59
    v_mul_f32 v61, v128, v128
    v_sub_f32 v129, v129, v59
    v_mul_f32 v60, v129, v129
    v_sub_f32 v130, v130, v59
    v_fmac_f32 v61, v130, v130
    v_sub_f32 v131, v131, v59
    v_fmac_f32 v60, v131, v131
    v_sub_f32 v132, v132, v59
    v_fmac_f32 v61, v132, v132
    v_sub_f32 v133, v133, v59
    v_fmac_f32 v60, v133, v133
    v_sub_f32 v134, v134, v59
    v_fmac_f32 v61, v134, v134
    v_sub_f32 v135, v135, v59
    v_fmac_f32 v60, v135, v135
    v_sub_f32 v136, v136, v59
    v_fmac_f32 v61, v136, v136
    v_sub_f32 v137, v137, v59
    v_fmac_f32 v60, v137, v137
    v_sub_f32 v138, v138, v59
    v_fmac_f32 v61, v138, v138
    v_sub_f32 v139, v139, v59
    v_fmac_f32 v60, v139, v139
    v_sub_f32 v140, v140, v59
    v_fmac_f32 v61, v140, v140
    v_sub_f32 v141, v141, v59
    v_fmac_f32 v60, v141, v141
    v_sub_f32 v142, v142, v59
    v_fmac_f32 v61, v142, v142
    v_sub_f32 v143, v143, v59
    v_fmac_f32 v60, v143, v143
    v_sub_f32 v144, v144, v59
    v_fmac_f32 v61, v144, v144
    v_sub_f32 v145, v145, v59
    v_fmac_f32 v60, v145, v145
    v_sub_f32 v146, v146, v59
    v_fmac_f32 v61, v146, v146
    v_sub_f32 v147, v147, v59
    v_fmac_f32 v60, v147, v147
    v_sub_f32 v148, v148, v59
    v_fmac_f32 v61, v148, v148
    v_sub_f32 v149, v149, v59
    v_fmac_f32 v60, v149, v149
    v_sub_f32 v150, v150, v59
    v_fmac_f32 v61, v150, v150
    v_sub_f32 v151, v151, v59
    v_fmac_f32 v60, v151, v151
    v_sub_f32 v152, v152, v59
    v_fmac_f32 v61, v152, v152
    v_sub_f32 v153, v153, v59
    v_fmac_f32 v60, v153, v153
    v_sub_f32 v154, v154, v59
    v_fmac_f32 v61, v154, v154
    v_sub_f32 v155, v155, v59
    v_fmac_f32 v60, v155, v155
    v_sub_f32 v156, v156, v59
    v_fmac_f32 v61, v156, v156
    v_sub_f32 v157, v157, v59
    v_fmac_f32 v60, v157, v157
    v_sub_f32 v158, v158, v59
    v_fmac_f32 v61, v158, v158
    v_sub_f32 v159, v159, v59
    v_fmac_f32 v60, v159, v159
    v_sub_f32 v160, v160, v59
    v_fmac_f32 v61, v160, v160
    v_sub_f32 v161, v161, v59
    v_fmac_f32 v60, v161, v161
    v_sub_f32 v162, v162, v59
    v_fmac_f32 v61, v162, v162
    v_sub_f32 v163, v163, v59
    v_fmac_f32 v60, v163, v163
    v_sub_f32 v164, v164, v59
    v_fmac_f32 v61, v164, v164
    v_sub_f32 v165, v165, v59
    v_fmac_f32 v60, v165, v165
    v_sub_f32 v166, v166, v59
    v_fmac_f32 v61, v166, v166
    v_sub_f32 v167, v167, v59
    v_fmac_f32 v60, v167, v167
    v_sub_f32 v168, v168, v59
    v_fmac_f32 v61, v168, v168
    v_sub_f32 v169, v169, v59
    v_fmac_f32 v60, v169, v169
    v_sub_f32 v170, v170, v59
    v_fmac_f32 v61, v170, v170
    v_sub_f32 v171, v171, v59
    v_fmac_f32 v60, v171, v171
    v_sub_f32 v172, v172, v59
    v_fmac_f32 v61, v172, v172
    v_sub_f32 v173, v173, v59
    v_fmac_f32 v60, v173, v173
    v_sub_f32 v174, v174, v59
    v_fmac_f32 v61, v174, v174
    v_sub_f32 v175, v175, v59
    v_fmac_f32 v60, v175, v175
    v_sub_f32 v176, v176, v59
    v_fmac_f32 v61, v176, v176
    v_sub_f32 v177, v177, v59
    v_fmac_f32 v60, v177, v177
    v_sub_f32 v178, v178, v59
    v_fmac_f32 v61, v178, v178
    v_sub_f32 v179, v179, v59
    v_fmac_f32 v60, v179, v179
    v_sub_f32 v180, v180, v59
    v_fmac_f32 v61, v180, v180
    v_sub_f32 v181, v181, v59
    v_fmac_f32 v60, v181, v181
    v_sub_f32 v182, v182, v59
    v_fmac_f32 v61, v182, v182
    v_sub_f32 v183, v183, v59
    v_fmac_f32 v60, v183, v183
    v_sub_f32 v184, v184, v59
    v_fmac_f32 v61, v184, v184
    v_sub_f32 v185, v185, v59
    v_fmac_f32 v60, v185, v185
    v_sub_f32 v186, v186, v59
    v_fmac_f32 v61, v186, v186
    v_sub_f32 v187, v187, v59
    v_fmac_f32 v60, v187, v187
    v_sub_f32 v188, v188, v59
    v_fmac_f32 v61, v188, v188
    v_sub_f32 v189, v189, v59
    v_fmac_f32 v60, v189, v189
    v_sub_f32 v190, v190, v59
    v_fmac_f32 v61, v190, v190
    v_sub_f32 v191, v191, v59
    v_fmac_f32 v60, v191, v191
    v_sub_f32 v192, v192, v59
    v_fmac_f32 v61, v192, v192
    v_sub_f32 v193, v193, v59
    v_fmac_f32 v60, v193, v193
    v_sub_f32 v194, v194, v59
    v_fmac_f32 v61, v194, v194
    v_sub_f32 v195, v195, v59
    v_fmac_f32 v60, v195, v195
    v_sub_f32 v196, v196, v59
    v_fmac_f32 v61, v196, v196
    v_sub_f32 v197, v197, v59
    v_fmac_f32 v60, v197, v197
    v_sub_f32 v198, v198, v59
    v_fmac_f32 v61, v198, v198
    v_sub_f32 v199, v199, v59
    v_fmac_f32 v60, v199, v199
    v_sub_f32 v200, v200, v59
    v_fmac_f32 v61, v200, v200
    v_sub_f32 v201, v201, v59
    v_fmac_f32 v60, v201, v201
    v_sub_f32 v202, v202, v59
    v_fmac_f32 v61, v202, v202
    v_sub_f32 v203, v203, v59
    v_fmac_f32 v60, v203, v203
    v_sub_f32 v204, v204, v59
    v_fmac_f32 v61, v204, v204
    v_sub_f32 v205, v205, v59
    v_fmac_f32 v60, v205, v205
    v_sub_f32 v206, v206, v59
    v_fmac_f32 v61, v206, v206
    v_sub_f32 v207, v207, v59
    v_fmac_f32 v60, v207, v207
    v_sub_f32 v208, v208, v59
    v_fmac_f32 v61, v208, v208
    v_sub_f32 v209, v209, v59
    v_fmac_f32 v60, v209, v209
    v_sub_f32 v210, v210, v59
    v_fmac_f32 v61, v210, v210
    v_sub_f32 v211, v211, v59
    v_fmac_f32 v60, v211, v211
    v_sub_f32 v212, v212, v59
    v_fmac_f32 v61, v212, v212
    v_sub_f32 v213, v213, v59
    v_fmac_f32 v60, v213, v213
    v_sub_f32 v214, v214, v59
    v_fmac_f32 v61, v214, v214
    v_sub_f32 v215, v215, v59
    v_fmac_f32 v60, v215, v215
    v_sub_f32 v216, v216, v59
    v_fmac_f32 v61, v216, v216
    v_sub_f32 v217, v217, v59
    v_fmac_f32 v60, v217, v217
    v_sub_f32 v218, v218, v59
    v_fmac_f32 v61, v218, v218
    v_sub_f32 v219, v219, v59
    v_fmac_f32 v60, v219, v219
    v_sub_f32 v220, v220, v59
    v_fmac_f32 v61, v220, v220
    v_sub_f32 v221, v221, v59
    v_fmac_f32 v60, v221, v221
    v_sub_f32 v222, v222, v59
    v_fmac_f32 v61, v222, v222
    v_sub_f32 v223, v223, v59
    v_fmac_f32 v60, v223, v223
    v_sub_f32 v224, v224, v59
    v_fmac_f32 v61, v224, v224
    v_sub_f32 v225, v225, v59
    v_fmac_f32 v60, v225, v225
    v_sub_f32 v226, v226, v59
    v_fmac_f32 v61, v226, v226
    v_sub_f32 v227, v227, v59
    v_fmac_f32 v60, v227, v227
    v_sub_f32 v228, v228, v59
    v_fmac_f32 v61, v228, v228
    v_sub_f32 v229, v229, v59
    v_fmac_f32 v60, v229, v229
    v_sub_f32 v230, v230, v59
    v_fmac_f32 v61, v230, v230
    v_sub_f32 v231, v231, v59
    v_fmac_f32 v60, v231, v231
    v_sub_f32 v232, v232, v59
    v_fmac_f32 v61, v232, v232
    v_sub_f32 v233, v233, v59
    v_fmac_f32 v60, v233, v233
    v_sub_f32 v234, v234, v59
    v_fmac_f32 v61, v234, v234
    v_sub_f32 v235, v235, v59
    v_fmac_f32 v60, v235, v235
    v_sub_f32 v236, v236, v59
    v_fmac_f32 v61, v236, v236
    v_sub_f32 v237, v237, v59
    v_fmac_f32 v60, v237, v237
    v_sub_f32 v238, v238, v59
    v_fmac_f32 v61, v238, v238
    v_sub_f32 v239, v239, v59
    v_fmac_f32 v60, v239, v239
    v_sub_f32 v240, v240, v59
    v_fmac_f32 v61, v240, v240
    v_sub_f32 v241, v241, v59
    v_fmac_f32 v60, v241, v241
    v_sub_f32 v242, v242, v59
    v_fmac_f32 v61, v242, v242
    v_sub_f32 v243, v243, v59
    v_fmac_f32 v60, v243, v243
    v_sub_f32 v244, v244, v59
    v_fmac_f32 v61, v244, v244
    v_sub_f32 v245, v245, v59
    v_fmac_f32 v60, v245, v245
    v_sub_f32 v246, v246, v59
    v_fmac_f32 v61, v246, v246
    v_sub_f32 v247, v247, v59
    v_fmac_f32 v60, v247, v247
    v_sub_f32 v248, v248, v59
    v_fmac_f32 v61, v248, v248
    v_sub_f32 v249, v249, v59
    v_fmac_f32 v60, v249, v249
    v_sub_f32 v250, v250, v59
    v_fmac_f32 v61, v250, v250
    v_sub_f32 v251, v251, v59
    v_fmac_f32 v60, v251, v251
    v_sub_f32 v252, v252, v59
    v_fmac_f32 v61, v252, v252
    v_sub_f32 v253, v253, v59
    v_fmac_f32 v60, v253, v253
    v_sub_f32 v254, v254, v59
    v_fmac_f32 v61, v254, v254
    v_sub_f32 v255, v255, v59
    v_fmac_f32 v60, v255, v255
    v_add_f32 v60, v60, v61
    ds_swizzle_b32 v61, v60 offset:1055
    s_waitcnt lgkmcnt(0)
    v_add_f32 v60, v60, v61
    ds_swizzle_b32 v61, v60 offset:2079
    s_waitcnt lgkmcnt(0)
    v_add_f32 v60, v60, v61
    v_mul_f32 v60, 0x3b000000, v60
    v_cvt_pk_bf16_f32 v59, v59, v59
    v_lshlrev_b32 v59, 16, v59
    v_cvt_pk_bf16_f32 v60, v60, v60
    v_lshlrev_b32 v60, 16, v60
    v_add_f32 v60, 0x3727c5ac, v60
    v_cvt_pk_bf16_f32 v60, v60, v60
    v_lshlrev_b32 v60, 16, v60
    v_sqrt_f32 v60, v60
    s_nop 0
    v_cvt_pk_bf16_f32 v60, v60, v60
    v_lshlrev_b32 v60, 16, v60
    v_lshrrev_b32 v59, 16, v59
    v_or_b32 v59, v60, v59
    v_lshlrev_b32 v56, 2, v56
    v_cmp_eq_u32 vcc, 0, v57
    s_and_saveexec_b64 s[58:59], vcc
    buffer_store_dword v59, v56, s[64:67], 0 offen sc0 sc1
    s_mov_b64 exec, s[58:59]
    s_waitcnt vmcnt(0)
    s_barrier
    s_cmp_lg_u32 s62, 0
    s_cbranch_scc1 L_sig_11
    s_memrealtime s[56:57]
    v_and_b32 v254, 31, v0
    v_lshlrev_b32 v254, 12, v254
    s_lshl_b32 s40, s61, 7
    s_add_u32 s40, s40, 32768
    s_waitcnt lgkmcnt(0)
    v_mov_b32 v250, s56
    v_mov_b32 v251, s57
    s_mov_b32 s58, -1
    s_mov_b32 s59, 0
    s_mov_b64 exec, s[58:59]
    buffer_store_dwordx2 v[250:251], v254, s[64:67], s40 offen sc0 sc1
    s_mov_b64 exec, -1
L_sig_11:
    s_setprio 0
    s_mov_b32 s8, s6
    s_mov_b32 s9, s7
    s_mov_b32 s10, 1835008
    s_mov_b32 s11, 0x00020000
    s_sub_u32 s40, s2, 480
    s_lshr_b32 s40, s40, 3
    s_and_b32 s41, s40, 1
    s_lshl_b32 s41, s41, 15
    s_lshr_b32 s40, s40, 1
    s_lshl_b32 s40, s40, 17
    s_add_u32 s40, s40, s41
    s_lshl_b32 s41, s62, 13
    s_add_u32 s40, s40, s41
    v_and_b32 v1, 63, v0
    v_lshlrev_b32 v1, 4, v1
    s_movk_i32 s41, 7
L_pf_12:
    s_waitcnt vmcnt(8)
    buffer_load_dwordx4 v[64:67], v1, s[8:11], s40 offen offset:0
    buffer_load_dwordx4 v[68:71], v1, s[8:11], s40 offen offset:1024
    buffer_load_dwordx4 v[72:75], v1, s[8:11], s40 offen offset:2048
    buffer_load_dwordx4 v[76:79], v1, s[8:11], s40 offen offset:3072
    s_add_u32 s40, s40, 4096
    buffer_load_dwordx4 v[80:83], v1, s[8:11], s40 offen offset:0
    buffer_load_dwordx4 v[84:87], v1, s[8:11], s40 offen offset:1024
    buffer_load_dwordx4 v[88:91], v1, s[8:11], s40 offen offset:2048
    buffer_load_dwordx4 v[92:95], v1, s[8:11], s40 offen offset:3072
    s_add_u32 s40, s40, 258048
    s_cmp_ge_u32 s40, 1835008
    s_cselect_b32 s42, 1769472, 0
    s_sub_u32 s40, s40, s42
    s_sub_u32 s41, s41, 1
    s_cmp_lg_u32 s41, 0
    s_cbranch_scc1 L_pf_12
    s_waitcnt vmcnt(0)
    s_load_dwordx2 s[6:7], s[0:1], 88
    s_load_dwordx2 s[48:49], s[0:1], 80
    s_load_dwordx2 s[50:51], s[0:1], 0
    s_load_dwordx2 s[52:53], s[0:1], 96
    s_load_dwordx2 s[70:71], s[68:69], 0
    s_mov_b32 s79, 62
    s_waitcnt lgkmcnt(0)
L_trs_13:
    s_cmp_lg_u64 s[70:71], 0
    s_cbranch_scc1 L_trso_14
    v_mov_b32 v248, 0
    global_load_dwordx2 v[248:249], v248, s[68:69] sc0 sc1
    s_waitcnt vmcnt(0)
    v_readfirstlane_b32 s70, v248
    v_readfirstlane_b32 s71, v249
    s_branch L_trs_13
L_trso_14:
    s_setprio 1
    s_branch L_fin
    s_endpgm
L_conv:
    s_cmp_ge_u32 s2, 16
    s_cbranch_scc1 L_cpf_15
    s_getpc_b64 s[8:9]
L_pc_16:
    s_sub_u32 s8, s8, L_pc_16-mid_kernel
    s_subb_u32 s9, s9, 0
    s_mov_b32 s10, L_end_fin-mid_kernel
    s_mov_b32 s11, 0x00020000
    s_lshr_b32 s12, s2, 3
    s_lshl_b32 s12, s12, 15
    v_lshlrev_b32 v1, 7, v0
    buffer_load_dword v255, v1, s[8:11], s12 offen
L_cpf_15:
    s_load_dwordx2 s[6:7], s[0:1], 48
    s_load_dwordx4 s[48:51], s[0:1], 8
    s_load_dwordx4 s[52:55], s[0:1], 24
    s_load_dwordx2 s[56:57], s[0:1], 40
    v_lshrrev_b32 v13, 6, v0
    v_and_b32 v12, 63, v0
    s_nop 0
    v_readfirstlane_b32 s3, v13
    s_lshr_b32 s20, s3, 1
    s_and_b32 s21, s3, 1
    s_lshl_b32 s22, s2, 1
    s_add_u32 s22, s22, s20
    s_waitcnt lgkmcnt(0)
    s_lshl_b32 s23, s2, 2
    s_load_dword s24, s[6:7], s23
    s_load_dword s60, s[56:57], s23
    s_or_b32 s40, s2, s3
    s_cmp_lg_u32 s40, 0
    s_cbranch_scc1 L_tr_17
    s_load_dwordx2 s[58:59], s[0:1], 104
    v_mov_b32 v250, s100
    v_mov_b32 v251, s101
    v_lshlrev_b32 v253, 7, v12
    s_waitcnt lgkmcnt(0)
    s_mov_b64 exec, 3
    global_store_dwordx2 v253, v[250:251], s[58:59] sc0 sc1
    s_mov_b64 exec, -1
L_tr_17:
    s_add_u32 s12, s4, 2097152
    s_addc_u32 s13, s5, 0
    s_mov_b32 s14, 2097152
    s_mov_b32 s15, 0x00020000
    s_add_u32 s16, s4, 18874368
    s_addc_u32 s17, s5, 0
    s_mov_b32 s18, 2097152
    s_mov_b32 s19, 0x00020000
    s_mov_b32 s28, s48
    s_mov_b32 s29, s49
    s_mov_b32 s30, 131072
    s_mov_b32 s31, 0x00020000
    s_mov_b32 s32, s50
    s_mov_b32 s33, s51
    s_mov_b32 s34, 131072
    s_mov_b32 s35, 0x00020000
    s_mov_b32 s36, s52
    s_mov_b32 s37, s53
    s_mov_b32 s38, 131072
    s_mov_b32 s39, 0x00020000
    s_mov_b32 s40, s54
    s_mov_b32 s41, s55
    s_mov_b32 s42, 131072
    s_mov_b32 s43, 0x00020000
    s_mul_i32 s25, s20, 40960
    v_lshlrev_b32 v3, 4, v12
    s_lshl_b32 s26, s2, 9
    v_lshl_add_u32 v2, v0, 1, s26
    buffer_load_ushort v4, v2, s[28:31], 0 offen
    buffer_load_ushort v5, v2, s[32:35], 0 offen
    buffer_load_ushort v6, v2, s[36:39], 0 offen
    buffer_load_ushort v7, v2, s[40:43], 0 offen
    s_mov_b32 s64, s4
    s_mov_b32 s65, s5
    s_mov_b32 s66, 196608
    s_mov_b32 s67, 0x00020000
    s_and_b32 s40, s2, 31
    s_lshl_b32 s40, s40, 12
    s_add_u32 s40, s40, 32768
    v_and_b32 v254, 31, v0
    v_lshl_add_u32 v254, v254, 7, s40
    s_cmp_lg_u32 s3, 0
    s_cselect_b32 s63, 1, 0
    s_lshl_b32 s27, s21, 7
    v_add_u32 v252, s27, v12
    v_lshlrev_b32 v252, 5, v252
    v_lshrrev_b32 v1, 1, v12
    v_lshlrev_b32 v1, 14, v1
    v_and_b32 v2, 1, v12
    v_lshl_add_u32 v253, v2, 4, v1
    v_mov_b32 v120, 0
    v_mov_b32 v121, 0
    v_mov_b32 v122, 0
    v_mov_b32 v123, 0
    s_mul_i32 s28, s21, 1280
    s_add_u32 s28, s28, s25
    s_add_u32 s28, s28, 33280
    v_add_u32 v1, s28, v3
    ds_write_b128 v1, v[120:123]
    v_cmp_gt_u32 vcc, 16, v12
    s_and_saveexec_b64 s[58:59], vcc
    ds_write_b128 v1, v[120:123] offset:1024
    s_mov_b64 exec, s[58:59]
    v_lshrrev_b32 v1, 2, v12
    s_movk_i32 s40, 4160
    v_mul_lo_u32 v1, v1, s40
    v_and_b32 v2, 3, v12
    v_lshl_add_u32 v1, v2, 4, v1
    s_add_u32 s28, s25, 4096
    v_add_u32 v124, s28, v1
    v_cmp_gt_u32 vcc, 16, v12
    s_and_saveexec_b64 s[58:59], vcc
    ds_write_b128 v124, v[120:123]
    s_mov_b64 exec, s[58:59]
    s_waitcnt lgkmcnt(0)
    s_lshl_b32 s41, s20, 4
    s_lshr_b32 s60, s60, s41
    s_lshl_b32 s60, s60, 16
    s_lshr_b32 s24, s24, s41
    s_lshl_b32 s24, s24, 16
    v_mov_b32 v8, s60
    v_mul_f32 v8, 0x3fb8aa3b, v8
    v_exp_f32 v8, v8
    s_nop 0
    v_cvt_pk_bf16_f32 v8, v8, v8
    v_lshlrev_b32 v8, 16, v8
    s_lshl_b32 s27, s21, 7
    v_add_u32 v24, s27, v12
    v_lshrrev_b32 v25, 2, v24
    v_and_b32 v26, 3, v24
    s_movk_i32 s40, 80
    v_mul_lo_u32 v25, v25, s40
    v_lshl_add_u32 v25, v26, 4, v25
    s_add_u32 s27, s25, 35840
    v_add_u32 v248, s27, v25
    s_lshl_b32 s40, s21, 12
    s_add_u32 s40, s40, s25
    v_mov_b32 v249, s40
    v_and_b32 v35, 15, v12
    v_lshrrev_b32 v34, 4, v12
    v_lshl_add_u32 v36, v34, 2, 0
    v_lshrrev_b32 v27, 3, v36
    v_and_b32 v28, 7, v36
    v_lshl_add_u32 v24, v27, 7, v28
    v_lshlrev_b32 v26, 7, v36
    v_add_u32 v26, 1024, v26
    v_lshrrev_b32 v27, 2, v36
    v_lshlrev_b32 v27, 7, v27
    v_and_b32 v28, 3, v36
    v_lshl_add_u32 v27, v28, 1, v27
    v_add_u32 v27, 256, v27
    v_lshrrev_b32 v25, 1, v36
    v_lshlrev_b32 v25, 7, v25
    v_and_b32 v28, 1, v36
    v_lshl_add_u32 v25, v28, 2, v25
    v_cmp_gt_u32 vcc, 8, v36
    s_nop 1
    v_cndmask_b32 v25, v25, v27, vcc
    v_lshlrev_b32 v24, 2, v24
    v_lshl_add_u32 v24, v35, 5, v24
    v_add_u32 v216, s40, v24
    v_lshrrev_b32 v26, 1, v26
    v_lshl_add_u32 v26, v35, 2, v26
    v_add_u32 v217, s40, v26
    v_lshlrev_b32 v27, 1, v25
    v_lshl_add_u32 v27, v35, 4, v27
    v_add_u32 v27, 512, v27
    v_lshl_add_u32 v28, v35, 3, v25
    v_add_u32 v28, 1536, v28
    v_cmp_gt_u32 vcc, 8, v36
    s_nop 1
    v_cndmask_b32 v27, v28, v27, vcc
    v_add_u32 v218, s40, v27
    v_lshl_add_u32 v36, v34, 2, 1
    v_lshrrev_b32 v27, 3, v36
    v_and_b32 v28, 7, v36
    v_lshl_add_u32 v24, v27, 7, v28
    v_lshlrev_b32 v26, 7, v36
    v_add_u32 v26, 1024, v26
    v_lshrrev_b32 v27, 2, v36
    v_lshlrev_b32 v27, 7, v27
    v_and_b32 v28, 3, v36
    v_lshl_add_u32 v27, v28, 1, v27
    v_add_u32 v27, 256, v27
    v_lshrrev_b32 v25, 1, v36
    v_lshlrev_b32 v25, 7, v25
    v_and_b32 v28, 1, v36
    v_lshl_add_u32 v25, v28, 2, v25
    v_cmp_gt_u32 vcc, 8, v36
    s_nop 1
    v_cndmask_b32 v25, v25, v27, vcc
    v_lshlrev_b32 v24, 2, v24
    v_lshl_add_u32 v24, v35, 5, v24
    v_add_u32 v219, s40, v24
    v_lshrrev_b32 v26, 1, v26
    v_lshl_add_u32 v26, v35, 2, v26
    v_add_u32 v220, s40, v26
    v_lshlrev_b32 v27, 1, v25
    v_lshl_add_u32 v27, v35, 4, v27
    v_add_u32 v27, 512, v27
    v_lshl_add_u32 v28, v35, 3, v25
    v_add_u32 v28, 1536, v28
    v_cmp_gt_u32 vcc, 8, v36
    s_nop 1
    v_cndmask_b32 v27, v28, v27, vcc
    v_add_u32 v221, s40, v27
    v_lshl_add_u32 v36, v34, 2, 2
    v_lshrrev_b32 v27, 3, v36
    v_and_b32 v28, 7, v36
    v_lshl_add_u32 v24, v27, 7, v28
    v_lshlrev_b32 v26, 7, v36
    v_add_u32 v26, 1024, v26
    v_lshrrev_b32 v27, 2, v36
    v_lshlrev_b32 v27, 7, v27
    v_and_b32 v28, 3, v36
    v_lshl_add_u32 v27, v28, 1, v27
    v_add_u32 v27, 256, v27
    v_lshrrev_b32 v25, 1, v36
    v_lshlrev_b32 v25, 7, v25
    v_and_b32 v28, 1, v36
    v_lshl_add_u32 v25, v28, 2, v25
    v_cmp_gt_u32 vcc, 8, v36
    s_nop 1
    v_cndmask_b32 v25, v25, v27, vcc
    v_lshlrev_b32 v24, 2, v24
    v_lshl_add_u32 v24, v35, 5, v24
    v_add_u32 v222, s40, v24
    v_lshrrev_b32 v26, 1, v26
    v_lshl_add_u32 v26, v35, 2, v26
    v_add_u32 v223, s40, v26
    v_lshlrev_b32 v27, 1, v25
    v_lshl_add_u32 v27, v35, 4, v27
    v_add_u32 v27, 512, v27
    v_lshl_add_u32 v28, v35, 3, v25
    v_add_u32 v28, 1536, v28
    v_cmp_gt_u32 vcc, 8, v36
    s_nop 1
    v_cndmask_b32 v27, v28, v27, vcc
    v_add_u32 v224, s40, v27
    v_lshl_add_u32 v36, v34, 2, 3
    v_lshrrev_b32 v27, 3, v36
    v_and_b32 v28, 7, v36
    v_lshl_add_u32 v24, v27, 7, v28
    v_lshlrev_b32 v26, 7, v36
    v_add_u32 v26, 1024, v26
    v_lshrrev_b32 v27, 2, v36
    v_lshlrev_b32 v27, 7, v27
    v_and_b32 v28, 3, v36
    v_lshl_add_u32 v27, v28, 1, v27
    v_add_u32 v27, 256, v27
    v_lshrrev_b32 v25, 1, v36
    v_lshlrev_b32 v25, 7, v25
    v_and_b32 v28, 1, v36
    v_lshl_add_u32 v25, v28, 2, v25
    v_cmp_gt_u32 vcc, 8, v36
    s_nop 1
    v_cndmask_b32 v25, v25, v27, vcc
    v_lshlrev_b32 v24, 2, v24
    v_lshl_add_u32 v24, v35, 5, v24
    v_add_u32 v225, s40, v24
    v_lshrrev_b32 v26, 1, v26
    v_lshl_add_u32 v26, v35, 2, v26
    v_add_u32 v226, s40, v26
    v_lshlrev_b32 v27, 1, v25
    v_lshl_add_u32 v27, v35, 4, v27
    v_add_u32 v27, 512, v27
    v_lshl_add_u32 v28, v35, 3, v25
    v_add_u32 v28, 1536, v28
    v_cmp_gt_u32 vcc, 8, v36
    s_nop 1
    v_cndmask_b32 v27, v28, v27, vcc
    v_add_u32 v227, s40, v27
    v_and_b32 v24, 127, v0
    v_lshlrev_b32 v25, 4, v24
    v_add_u32 v245, s25, v25
    v_sub_u32 v25, 2047, v25
    v_mov_b32 v26, 0
    v_cmp_le_u32 vcc, 256, v25
    s_nop 1
    v_addc_co_u32 v26, vcc, 0, v26, vcc
    v_cmp_le_u32 vcc, 512, v25
    s_nop 1
    v_addc_co_u32 v26, vcc, 0, v26, vcc
    v_cmp_le_u32 vcc, 1024, v25
    s_nop 1
    v_addc_co_u32 v26, vcc, 0, v26, vcc
    v_lshlrev_b32 v27, v26, 1
    v_lshrrev_b32 v27, 1, v27
    v_cmp_ne_u32 vcc, 0, v26
    s_nop 1
    v_cndmask_b32 v28, 0, 1, vcc
    v_sub_u32 v27, v27, v28
    v_lshlrev_b32 v29, 7, v28
    v_lshlrev_b32 v30, 8, v26
    v_sub_u32 v30, v30, v29
    v_lshlrev_b32 v30, 2, v30
    v_add_u32 v30, s25, v30
    v_subrev_u32 v31, 0, v25
    v_lshrrev_b32 v32, v26, v31
    v_and_b32 v32, v32, v28
    v_add3_u32 v32, v32, v31, v27
    v_lshrrev_b32 v32, v26, v32
    v_lshl_add_u32 v228, v32, 2, v30
    v_subrev_u32 v31, 1, v25
    v_lshrrev_b32 v32, v26, v31
    v_and_b32 v32, v32, v28
    v_add3_u32 v32, v32, v31, v27
    v_lshrrev_b32 v32, v26, v32
    v_lshl_add_u32 v229, v32, 2, v30
    v_subrev_u32 v31, 2, v25
    v_lshrrev_b32 v32, v26, v31
    v_and_b32 v32, v32, v28
    v_add3_u32 v32, v32, v31, v27
    v_lshrrev_b32 v32, v26, v32
    v_lshl_add_u32 v230, v32, 2, v30
    v_subrev_u32 v31, 3, v25
    v_lshrrev_b32 v32, v26, v31
    v_and_b32 v32, v32, v28
    v_add3_u32 v32, v32, v31, v27
    v_lshrrev_b32 v32, v26, v32
    v_lshl_add_u32 v231, v32, 2, v30
    v_subrev_u32 v31, 4, v25
    v_lshrrev_b32 v32, v26, v31
    v_and_b32 v32, v32, v28
    v_add3_u32 v32, v32, v31, v27
    v_lshrrev_b32 v32, v26, v32
    v_lshl_add_u32 v232, v32, 2, v30
    v_subrev_u32 v31, 5, v25
    v_lshrrev_b32 v32, v26, v31
    v_and_b32 v32, v32, v28
    v_add3_u32 v32, v32, v31, v27
    v_lshrrev_b32 v32, v26, v32
    v_lshl_add_u32 v233, v32, 2, v30
    v_subrev_u32 v31, 6, v25
    v_lshrrev_b32 v32, v26, v31
    v_and_b32 v32, v32, v28
    v_add3_u32 v32, v32, v31, v27
    v_lshrrev_b32 v32, v26, v32
    v_lshl_add_u32 v234, v32, 2, v30
    v_subrev_u32 v31, 7, v25
    v_lshrrev_b32 v32, v26, v31
    v_and_b32 v32, v32, v28
    v_add3_u32 v32, v32, v31, v27
    v_lshrrev_b32 v32, v26, v32
    v_lshl_add_u32 v235, v32, 2, v30
    v_subrev_u32 v31, 8, v25
    v_lshrrev_b32 v32, v26, v31
    v_and_b32 v32, v32, v28
    v_add3_u32 v32, v32, v31, v27
    v_lshrrev_b32 v32, v26, v32
    v_lshl_add_u32 v236, v32, 2, v30
    v_subrev_u32 v31, 9, v25
    v_lshrrev_b32 v32, v26, v31
    v_and_b32 v32, v32, v28
    v_add3_u32 v32, v32, v31, v27
    v_lshrrev_b32 v32, v26, v32
    v_lshl_add_u32 v237, v32, 2, v30
    v_subrev_u32 v31, 10, v25
    v_lshrrev_b32 v32, v26, v31
    v_and_b32 v32, v32, v28
    v_add3_u32 v32, v32, v31, v27
    v_lshrrev_b32 v32, v26, v32
    v_lshl_add_u32 v238, v32, 2, v30
    v_subrev_u32 v31, 11, v25
    v_lshrrev_b32 v32, v26, v31
    v_and_b32 v32, v32, v28
    v_add3_u32 v32, v32, v31, v27
    v_lshrrev_b32 v32, v26, v32
    v_lshl_add_u32 v239, v32, 2, v30
    v_subrev_u32 v31, 12, v25
    v_lshrrev_b32 v32, v26, v31
    v_and_b32 v32, v32, v28
    v_add3_u32 v32, v32, v31, v27
    v_lshrrev_b32 v32, v26, v32
    v_lshl_add_u32 v240, v32, 2, v30
    v_subrev_u32 v31, 13, v25
    v_lshrrev_b32 v32, v26, v31
    v_and_b32 v32, v32, v28
    v_add3_u32 v32, v32, v31, v27
    v_lshrrev_b32 v32, v26, v32
    v_lshl_add_u32 v241, v32, 2, v30
    v_subrev_u32 v31, 14, v25
    v_lshrrev_b32 v32, v26, v31
    v_and_b32 v32, v32, v28
    v_add3_u32 v32, v32, v31, v27
    v_lshrrev_b32 v32, v26, v32
    v_lshl_add_u32 v242, v32, 2, v30
    v_subrev_u32 v31, 15, v25
    v_lshrrev_b32 v32, v26, v31
    v_and_b32 v32, v32, v28
    v_add3_u32 v32, v32, v31, v27
    v_lshrrev_b32 v32, v26, v32
    v_lshl_add_u32 v243, v32, 2, v30
    v_lshlrev_b32 v24, 5, v24
    v_add_u32 v244, s25, v24
    v_and_b32 v14, 31, v12
    v_lshrrev_b32 v15, 5, v12
    v_and_b32 v24, 7, v14
    v_sub_u32 v24, 7, v24
    s_movk_i32 s40, 4160
    v_mul_lo_u32 v24, v24, s40
    v_lshrrev_b32 v25, 3, v14
    v_lshlrev_b32 v25, 4, v25
    v_sub_u32 v24, v24, v25
    v_lshl_add_u32 v24, v15, 4, v24
    s_lshl_b32 s27, s21, 5
    s_add_u32 s27, s27, s25
    v_add_u32 v246, s27, v24
    s_movk_i32 s40, 80
    v_mul_lo_u32 v25, v14, s40
    v_lshl_add_u32 v25, v15, 4, v25
    s_add_u32 s27, s27, 33280
    v_add_u32 v247, s27, v25
    s_waitcnt vmcnt(0)
    v_lshlrev_b32 v4, 16, v4
    v_lshlrev_b32 v5, 16, v5
    v_lshlrev_b32 v6, 16, v6
    v_lshlrev_b32 v7, 16, v7
    v_mul_f32 v4, 0x3fb8aa3b, v4
    v_exp_f32 v4, v4
    s_nop 0
    v_cvt_pk_bf16_f32 v4, v4, v4
    v_lshlrev_b32 v4, 16, v4
    v_mul_f32 v4, v4, v8
    v_mul_f32 v16, 0xbfb8aa3b, v4
    v_mov_b32 v9, s60
    v_mul_f32 v9, 0x3fb8aa3b, v9
    v_exp_f32 v9, v9
    s_nop 0
    v_cvt_pk_bf16_f32 v9, v9, v9
    v_lshlrev_b32 v9, 16, v9
    v_mul_f32 v5, v5, v9
    v_mul_f32 v17, 0x3e22f983, v5
    v_mul_f32 v6, v6, v9
    v_mul_f32 v7, v7, v9
    v_add_f32 v18, v6, v6
    v_add_f32 v19, v7, v7
    v_and_b32 v1, 127, v0
    v_lshlrev_b32 v1, 4, v1
    v_add_u32 v1, s25, v1
    ds_write_b128 v1, v[16:19] offset:24832
    s_waitcnt lgkmcnt(0)
    s_barrier
    v_and_b32 v3, 15, v12
    v_lshrrev_b32 v4, 4, v12
    v_lshrrev_b32 v5, 3, v3
    v_and_b32 v6, 7, v3
    v_lshl_add_u32 v20, v5, 7, v6
    v_lshlrev_b32 v22, 7, v3
    v_add_u32 v22, 1024, v22
    v_lshrrev_b32 v5, 2, v3
    v_lshlrev_b32 v5, 7, v5
    v_and_b32 v6, 3, v3
    v_lshl_add_u32 v5, v6, 1, v5
    v_add_u32 v5, 256, v5
    v_lshrrev_b32 v21, 1, v3
    v_lshlrev_b32 v21, 7, v21
    v_and_b32 v6, 1, v3
    v_lshl_add_u32 v21, v6, 2, v21
    v_cmp_gt_u32 vcc, 8, v3
    s_nop 1
    v_cndmask_b32 v21, v21, v5, vcc
    v_lshlrev_b32 v23, 3, v3
    v_cvt_f32_u32 v20, v20
    v_cvt_f32_u32 v21, v21
    v_cvt_f32_u32 v22, v22
    v_cvt_f32_u32 v23, v23
    s_lshl_b32 s40, s21, 10
    s_add_u32 s40, s40, s25
    v_lshl_add_u32 v19, v4, 4, s40
    v_mov_b32 v40, 0
    v_mov_b32 v41, 0
    v_mov_b32 v42, 0
    v_mov_b32 v43, 0
    v_mov_b32 v44, 0
    v_mov_b32 v45, 0
    v_mov_b32 v46, 0
    v_mov_b32 v47, 0
    v_mov_b32 v48, 0
    v_mov_b32 v49, 0
    v_mov_b32 v50, 0
    v_mov_b32 v51, 0
    ds_read_b128 v[24:27], v19 offset:24832
    ds_read_b128 v[28:31], v19 offset:24896
    s_waitcnt lgkmcnt(1)
    v_mul_f32 v104, v24, v23
    v_mul_f32 v105, v25, v23
    v_mul_f32 v108, v24, v20
    v_mul_f32 v109, v25, v20
    v_mul_f32 v112, v24, v21
    v_mul_f32 v113, v25, v21
    v_mul_f32 v116, v24, v22
    v_mul_f32 v117, v25, v22
    v_exp_f32 v104, v104
    v_fract_f32 v105, v105
    v_exp_f32 v108, v108
    v_fract_f32 v109, v109
    v_exp_f32 v112, v112
    v_fract_f32 v113, v113
    v_exp_f32 v116, v116
    v_fract_f32 v117, v117
    v_cos_f32 v106, v105
    v_sin_f32 v107, v105
    v_cos_f32 v110, v109
    v_sin_f32 v111, v109
    v_cos_f32 v114, v113
    v_sin_f32 v115, v113
    v_cos_f32 v118, v117
    v_sin_f32 v119, v117
    v_mul_f32 v64, v104, v106
    v_mul_f32 v65, v104, v107
    v_mul_f32 v56, v108, v110
    v_mul_f32 v57, v108, v111
    v_mul_f32 v58, v112, v114
    v_mul_f32 v59, v112, v115
    v_mul_f32 v60, v116, v118
    v_mul_f32 v61, v116, v119
    v_mul_f32 v66, v65, v27
    v_mul_f32 v67, v65, v26
    v_fma_f32 v62, v64, v26, -v66
    v_fma_f32 v63, -v64, v27, -v67
    v_cvt_pk_bf16_f32 v128, v56, v57
    v_cvt_pk_bf16_f32 v136, v58, v59
    v_cvt_pk_bf16_f32 v144, v60, v61
    v_cvt_pk_bf16_f32 v152, v62, v63
    v_lshlrev_b32 v72, 16, v128
    v_and_b32 v73, 0xffff0000, v128
    v_lshlrev_b32 v74, 16, v136
    v_and_b32 v75, 0xffff0000, v136
    v_lshlrev_b32 v76, 16, v144
    v_and_b32 v77, 0xffff0000, v144
    v_lshlrev_b32 v78, 16, v152
    v_and_b32 v79, 0xffff0000, v152
    v_sub_f32 v72, v56, v72
    v_sub_f32 v73, v57, v73
    v_sub_f32 v74, v58, v74
    v_sub_f32 v75, v59, v75
    v_sub_f32 v76, v60, v76
    v_sub_f32 v77, v61, v77
    v_sub_f32 v78, v62, v78
    v_sub_f32 v79, v63, v79
    v_cvt_pk_bf16_f32 v132, v72, v73
    v_cvt_pk_bf16_f32 v140, v74, v75
    v_cvt_pk_bf16_f32 v148, v76, v77
    v_cvt_pk_bf16_f32 v156, v78, v79
    ds_read_b128 v[24:27], v19 offset:24960
    s_waitcnt lgkmcnt(1)
    v_mul_f32 v104, v28, v23
    v_mul_f32 v105, v29, v23
    v_mul_f32 v108, v28, v20
    v_mul_f32 v109, v29, v20
    v_mul_f32 v112, v28, v21
    v_mul_f32 v113, v29, v21
    v_mul_f32 v116, v28, v22
    v_mul_f32 v117, v29, v22
    v_exp_f32 v104, v104
    v_fract_f32 v105, v105
    v_exp_f32 v108, v108
    v_fract_f32 v109, v109
    v_exp_f32 v112, v112
    v_fract_f32 v113, v113
    v_exp_f32 v116, v116
    v_fract_f32 v117, v117
    v_cos_f32 v106, v105
    v_sin_f32 v107, v105
    v_cos_f32 v110, v109
    v_sin_f32 v111, v109
    v_cos_f32 v114, v113
    v_sin_f32 v115, v113
    v_cos_f32 v118, v117
    v_sin_f32 v119, v117
    v_mul_f32 v64, v104, v106
    v_mul_f32 v65, v104, v107
    v_mul_f32 v56, v108, v110
    v_mul_f32 v57, v108, v111
    v_mul_f32 v58, v112, v114
    v_mul_f32 v59, v112, v115
    v_mul_f32 v60, v116, v118
    v_mul_f32 v61, v116, v119
    v_mul_f32 v66, v65, v31
    v_mul_f32 v67, v65, v30
    v_fma_f32 v62, v64, v30, -v66
    v_fma_f32 v63, -v64, v31, -v67
    v_cvt_pk_bf16_f32 v129, v56, v57
    v_cvt_pk_bf16_f32 v137, v58, v59
    v_cvt_pk_bf16_f32 v145, v60, v61
    v_cvt_pk_bf16_f32 v153, v62, v63
    v_lshlrev_b32 v72, 16, v129
    v_and_b32 v73, 0xffff0000, v129
    v_lshlrev_b32 v74, 16, v137
    v_and_b32 v75, 0xffff0000, v137
    v_lshlrev_b32 v76, 16, v145
    v_and_b32 v77, 0xffff0000, v145
    v_lshlrev_b32 v78, 16, v153
    v_and_b32 v79, 0xffff0000, v153
    v_sub_f32 v72, v56, v72
    v_sub_f32 v73, v57, v73
    v_sub_f32 v74, v58, v74
    v_sub_f32 v75, v59, v75
    v_sub_f32 v76, v60, v76
    v_sub_f32 v77, v61, v77
    v_sub_f32 v78, v62, v78
    v_sub_f32 v79, v63, v79
    v_cvt_pk_bf16_f32 v133, v72, v73
    v_cvt_pk_bf16_f32 v141, v74, v75
    v_cvt_pk_bf16_f32 v149, v76, v77
    v_cvt_pk_bf16_f32 v157, v78, v79
    ds_read_b128 v[28:31], v19 offset:25024
    s_waitcnt lgkmcnt(1)
    v_mul_f32 v104, v24, v23
    v_mul_f32 v105, v25, v23
    v_mul_f32 v108, v24, v20
    v_mul_f32 v109, v25, v20
    v_mul_f32 v112, v24, v21
    v_mul_f32 v113, v25, v21
    v_mul_f32 v116, v24, v22
    v_mul_f32 v117, v25, v22
    v_exp_f32 v104, v104
    v_fract_f32 v105, v105
    v_exp_f32 v108, v108
    v_fract_f32 v109, v109
    v_exp_f32 v112, v112
    v_fract_f32 v113, v113
    v_exp_f32 v116, v116
    v_fract_f32 v117, v117
    v_cos_f32 v106, v105
    v_sin_f32 v107, v105
    v_cos_f32 v110, v109
    v_sin_f32 v111, v109
    v_cos_f32 v114, v113
    v_sin_f32 v115, v113
    v_cos_f32 v118, v117
    v_sin_f32 v119, v117
    v_mul_f32 v64, v104, v106
    v_mul_f32 v65, v104, v107
    v_mul_f32 v56, v108, v110
    v_mul_f32 v57, v108, v111
    v_mul_f32 v58, v112, v114
    v_mul_f32 v59, v112, v115
    v_mul_f32 v60, v116, v118
    v_mul_f32 v61, v116, v119
    v_mul_f32 v66, v65, v27
    v_mul_f32 v67, v65, v26
    v_fma_f32 v62, v64, v26, -v66
    v_fma_f32 v63, -v64, v27, -v67
    v_cvt_pk_bf16_f32 v130, v56, v57
    v_cvt_pk_bf16_f32 v138, v58, v59
    v_cvt_pk_bf16_f32 v146, v60, v61
    v_cvt_pk_bf16_f32 v154, v62, v63
    v_lshlrev_b32 v72, 16, v130
    v_and_b32 v73, 0xffff0000, v130
    v_lshlrev_b32 v74, 16, v138
    v_and_b32 v75, 0xffff0000, v138
    v_lshlrev_b32 v76, 16, v146
    v_and_b32 v77, 0xffff0000, v146
    v_lshlrev_b32 v78, 16, v154
    v_and_b32 v79, 0xffff0000, v154
    v_sub_f32 v72, v56, v72
    v_sub_f32 v73, v57, v73
    v_sub_f32 v74, v58, v74
    v_sub_f32 v75, v59, v75
    v_sub_f32 v76, v60, v76
    v_sub_f32 v77, v61, v77
    v_sub_f32 v78, v62, v78
    v_sub_f32 v79, v63, v79
    v_cvt_pk_bf16_f32 v134, v72, v73
    v_cvt_pk_bf16_f32 v142, v74, v75
    v_cvt_pk_bf16_f32 v150, v76, v77
    v_cvt_pk_bf16_f32 v158, v78, v79
    ds_read_b128 v[24:27], v19 offset:25088
    s_waitcnt lgkmcnt(1)
    v_mul_f32 v104, v28, v23
    v_mul_f32 v105, v29, v23
    v_mul_f32 v108, v28, v20
    v_mul_f32 v109, v29, v20
    v_mul_f32 v112, v28, v21
    v_mul_f32 v113, v29, v21
    v_mul_f32 v116, v28, v22
    v_mul_f32 v117, v29, v22
    v_exp_f32 v104, v104
    v_fract_f32 v105, v105
    v_exp_f32 v108, v108
    v_fract_f32 v109, v109
    v_exp_f32 v112, v112
    v_fract_f32 v113, v113
    v_exp_f32 v116, v116
    v_fract_f32 v117, v117
    v_cos_f32 v106, v105
    v_sin_f32 v107, v105
    v_cos_f32 v110, v109
    v_sin_f32 v111, v109
    v_cos_f32 v114, v113
    v_sin_f32 v115, v113
    v_cos_f32 v118, v117
    v_sin_f32 v119, v117
    v_mul_f32 v64, v104, v106
    v_mul_f32 v65, v104, v107
    v_mul_f32 v56, v108, v110
    v_mul_f32 v57, v108, v111
    v_mul_f32 v58, v112, v114
    v_mul_f32 v59, v112, v115
    v_mul_f32 v60, v116, v118
    v_mul_f32 v61, v116, v119
    v_mul_f32 v66, v65, v31
    v_mul_f32 v67, v65, v30
    v_fma_f32 v62, v64, v30, -v66
    v_fma_f32 v63, -v64, v31, -v67
    v_cvt_pk_bf16_f32 v131, v56, v57
    v_cvt_pk_bf16_f32 v139, v58, v59
    v_cvt_pk_bf16_f32 v147, v60, v61
    v_cvt_pk_bf16_f32 v155, v62, v63
    v_lshlrev_b32 v72, 16, v131
    v_and_b32 v73, 0xffff0000, v131
    v_lshlrev_b32 v74, 16, v139
    v_and_b32 v75, 0xffff0000, v139
    v_lshlrev_b32 v76, 16, v147
    v_and_b32 v77, 0xffff0000, v147
    v_lshlrev_b32 v78, 16, v155
    v_and_b32 v79, 0xffff0000, v155
    v_sub_f32 v72, v56, v72
    v_sub_f32 v73, v57, v73
    v_sub_f32 v74, v58, v74
    v_sub_f32 v75, v59, v75
    v_sub_f32 v76, v60, v76
    v_sub_f32 v77, v61, v77
    v_sub_f32 v78, v62, v78
    v_sub_f32 v79, v63, v79
    v_cvt_pk_bf16_f32 v135, v72, v73
    v_cvt_pk_bf16_f32 v143, v74, v75
    v_cvt_pk_bf16_f32 v151, v76, v77
    v_cvt_pk_bf16_f32 v159, v78, v79
    ds_read_b128 v[28:31], v19 offset:25152
    s_waitcnt lgkmcnt(1)
    v_mul_f32 v104, v24, v23
    v_mul_f32 v105, v25, v23
    v_mul_f32 v108, v24, v20
    v_mul_f32 v109, v25, v20
    v_mfma_f32_16x16x32_bf16 v[40:43], v[128:131], v[152:155], v[40:43]
    v_mul_f32 v112, v24, v21
    v_mul_f32 v113, v25, v21
    v_mul_f32 v116, v24, v22
    v_mul_f32 v117, v25, v22
    v_mfma_f32_16x16x32_bf16 v[44:47], v[136:139], v[152:155], v[44:47]
    v_exp_f32 v104, v104
    v_fract_f32 v105, v105
    v_exp_f32 v108, v108
    v_fract_f32 v109, v109
    v_mfma_f32_16x16x32_bf16 v[48:51], v[144:147], v[152:155], v[48:51]
    v_exp_f32 v112, v112
    v_fract_f32 v113, v113
    v_exp_f32 v116, v116
    v_fract_f32 v117, v117
    v_mfma_f32_16x16x32_bf16 v[40:43], v[128:131], v[156:159], v[40:43]
    v_cos_f32 v106, v105
    v_sin_f32 v107, v105
    v_cos_f32 v110, v109
    v_sin_f32 v111, v109
    v_mfma_f32_16x16x32_bf16 v[44:47], v[136:139], v[156:159], v[44:47]
    v_cos_f32 v114, v113
    v_sin_f32 v115, v113
    v_cos_f32 v118, v117
    v_sin_f32 v119, v117
    v_mfma_f32_16x16x32_bf16 v[48:51], v[144:147], v[156:159], v[48:51]
    v_mul_f32 v64, v104, v106
    v_mul_f32 v65, v104, v107
    v_mul_f32 v56, v108, v110
    v_mul_f32 v57, v108, v111
    v_mfma_f32_16x16x32_bf16 v[40:43], v[132:135], v[152:155], v[40:43]
    v_mul_f32 v58, v112, v114
    v_mul_f32 v59, v112, v115
    v_mul_f32 v60, v116, v118
    v_mul_f32 v61, v116, v119
    v_mfma_f32_16x16x32_bf16 v[44:47], v[140:143], v[152:155], v[44:47]
    v_mul_f32 v66, v65, v27
    v_mul_f32 v67, v65, v26
    v_fma_f32 v62, v64, v26, -v66
    v_fma_f32 v63, -v64, v27, -v67
    v_mfma_f32_16x16x32_bf16 v[48:51], v[148:151], v[152:155], v[48:51]
    v_cvt_pk_bf16_f32 v160, v56, v57
    v_cvt_pk_bf16_f32 v168, v58, v59
    v_cvt_pk_bf16_f32 v176, v60, v61
    v_cvt_pk_bf16_f32 v184, v62, v63
    v_lshlrev_b32 v72, 16, v160
    v_and_b32 v73, 0xffff0000, v160
    v_lshlrev_b32 v74, 16, v168
    v_and_b32 v75, 0xffff0000, v168
    v_lshlrev_b32 v76, 16, v176
    v_and_b32 v77, 0xffff0000, v176
    v_lshlrev_b32 v78, 16, v184
    v_and_b32 v79, 0xffff0000, v184
    v_sub_f32 v72, v56, v72
    v_sub_f32 v73, v57, v73
    v_sub_f32 v74, v58, v74
    v_sub_f32 v75, v59, v75
    v_sub_f32 v76, v60, v76
    v_sub_f32 v77, v61, v77
    v_sub_f32 v78, v62, v78
    v_sub_f32 v79, v63, v79
    v_cvt_pk_bf16_f32 v164, v72, v73
    v_cvt_pk_bf16_f32 v172, v74, v75
    v_cvt_pk_bf16_f32 v180, v76, v77
    v_cvt_pk_bf16_f32 v188, v78, v79
    ds_read_b128 v[24:27], v19 offset:25216
    s_waitcnt lgkmcnt(1)
    v_mul_f32 v104, v28, v23
    v_mul_f32 v105, v29, v23
    v_mul_f32 v108, v28, v20
    v_mul_f32 v109, v29, v20
    v_mul_f32 v112, v28, v21
    v_mul_f32 v113, v29, v21
    v_mul_f32 v116, v28, v22
    v_mul_f32 v117, v29, v22
    v_exp_f32 v104, v104
    v_fract_f32 v105, v105
    v_exp_f32 v108, v108
    v_fract_f32 v109, v109
    v_exp_f32 v112, v112
    v_fract_f32 v113, v113
    v_exp_f32 v116, v116
    v_fract_f32 v117, v117
    v_cos_f32 v106, v105
    v_sin_f32 v107, v105
    v_cos_f32 v110, v109
    v_sin_f32 v111, v109
    v_cos_f32 v114, v113
    v_sin_f32 v115, v113
    v_cos_f32 v118, v117
    v_sin_f32 v119, v117
    v_mul_f32 v64, v104, v106
    v_mul_f32 v65, v104, v107
    v_mul_f32 v56, v108, v110
    v_mul_f32 v57, v108, v111
    v_mul_f32 v58, v112, v114
    v_mul_f32 v59, v112, v115
    v_mul_f32 v60, v116, v118
    v_mul_f32 v61, v116, v119
    v_mul_f32 v66, v65, v31
    v_mul_f32 v67, v65, v30
    v_fma_f32 v62, v64, v30, -v66
    v_fma_f32 v63, -v64, v31, -v67
    v_cvt_pk_bf16_f32 v161, v56, v57
    v_cvt_pk_bf16_f32 v169, v58, v59
    v_cvt_pk_bf16_f32 v177, v60, v61
    v_cvt_pk_bf16_f32 v185, v62, v63
    v_lshlrev_b32 v72, 16, v161
    v_and_b32 v73, 0xffff0000, v161
    v_lshlrev_b32 v74, 16, v169
    v_and_b32 v75, 0xffff0000, v169
    v_lshlrev_b32 v76, 16, v177
    v_and_b32 v77, 0xffff0000, v177
    v_lshlrev_b32 v78, 16, v185
    v_and_b32 v79, 0xffff0000, v185
    v_sub_f32 v72, v56, v72
    v_sub_f32 v73, v57, v73
    v_sub_f32 v74, v58, v74
    v_sub_f32 v75, v59, v75
    v_sub_f32 v76, v60, v76
    v_sub_f32 v77, v61, v77
    v_sub_f32 v78, v62, v78
    v_sub_f32 v79, v63, v79
    v_cvt_pk_bf16_f32 v165, v72, v73
    v_cvt_pk_bf16_f32 v173, v74, v75
    v_cvt_pk_bf16_f32 v181, v76, v77
    v_cvt_pk_bf16_f32 v189, v78, v79
    ds_read_b128 v[28:31], v19 offset:25280
    s_waitcnt lgkmcnt(1)
    v_mul_f32 v104, v24, v23
    v_mul_f32 v105, v25, v23
    v_mul_f32 v108, v24, v20
    v_mul_f32 v109, v25, v20
    v_mul_f32 v112, v24, v21
    v_mul_f32 v113, v25, v21
    v_mul_f32 v116, v24, v22
    v_mul_f32 v117, v25, v22
    v_exp_f32 v104, v104
    v_fract_f32 v105, v105
    v_exp_f32 v108, v108
    v_fract_f32 v109, v109
    v_exp_f32 v112, v112
    v_fract_f32 v113, v113
    v_exp_f32 v116, v116
    v_fract_f32 v117, v117
    v_cos_f32 v106, v105
    v_sin_f32 v107, v105
    v_cos_f32 v110, v109
    v_sin_f32 v111, v109
    v_cos_f32 v114, v113
    v_sin_f32 v115, v113
    v_cos_f32 v118, v117
    v_sin_f32 v119, v117
    v_mul_f32 v64, v104, v106
    v_mul_f32 v65, v104, v107
    v_mul_f32 v56, v108, v110
    v_mul_f32 v57, v108, v111
    v_mul_f32 v58, v112, v114
    v_mul_f32 v59, v112, v115
    v_mul_f32 v60, v116, v118
    v_mul_f32 v61, v116, v119
    v_mul_f32 v66, v65, v27
    v_mul_f32 v67, v65, v26
    v_fma_f32 v62, v64, v26, -v66
    v_fma_f32 v63, -v64, v27, -v67
    v_cvt_pk_bf16_f32 v162, v56, v57
    v_cvt_pk_bf16_f32 v170, v58, v59
    v_cvt_pk_bf16_f32 v178, v60, v61
    v_cvt_pk_bf16_f32 v186, v62, v63
    v_lshlrev_b32 v72, 16, v162
    v_and_b32 v73, 0xffff0000, v162
    v_lshlrev_b32 v74, 16, v170
    v_and_b32 v75, 0xffff0000, v170
    v_lshlrev_b32 v76, 16, v178
    v_and_b32 v77, 0xffff0000, v178
    v_lshlrev_b32 v78, 16, v186
    v_and_b32 v79, 0xffff0000, v186
    v_sub_f32 v72, v56, v72
    v_sub_f32 v73, v57, v73
    v_sub_f32 v74, v58, v74
    v_sub_f32 v75, v59, v75
    v_sub_f32 v76, v60, v76
    v_sub_f32 v77, v61, v77
    v_sub_f32 v78, v62, v78
    v_sub_f32 v79, v63, v79
    v_cvt_pk_bf16_f32 v166, v72, v73
    v_cvt_pk_bf16_f32 v174, v74, v75
    v_cvt_pk_bf16_f32 v182, v76, v77
    v_cvt_pk_bf16_f32 v190, v78, v79
    ds_read_b128 v[24:27], v19 offset:25344
    s_waitcnt lgkmcnt(1)
    v_mul_f32 v104, v28, v23
    v_mul_f32 v105, v29, v23
    v_mul_f32 v108, v28, v20
    v_mul_f32 v109, v29, v20
    v_mul_f32 v112, v28, v21
    v_mul_f32 v113, v29, v21
    v_mul_f32 v116, v28, v22
    v_mul_f32 v117, v29, v22
    v_exp_f32 v104, v104
    v_fract_f32 v105, v105
    v_exp_f32 v108, v108
    v_fract_f32 v109, v109
    v_exp_f32 v112, v112
    v_fract_f32 v113, v113
    v_exp_f32 v116, v116
    v_fract_f32 v117, v117
    v_cos_f32 v106, v105
    v_sin_f32 v107, v105
    v_cos_f32 v110, v109
    v_sin_f32 v111, v109
    v_cos_f32 v114, v113
    v_sin_f32 v115, v113
    v_cos_f32 v118, v117
    v_sin_f32 v119, v117
    v_mul_f32 v64, v104, v106
    v_mul_f32 v65, v104, v107
    v_mul_f32 v56, v108, v110
    v_mul_f32 v57, v108, v111
    v_mul_f32 v58, v112, v114
    v_mul_f32 v59, v112, v115
    v_mul_f32 v60, v116, v118
    v_mul_f32 v61, v116, v119
    v_mul_f32 v66, v65, v31
    v_mul_f32 v67, v65, v30
    v_fma_f32 v62, v64, v30, -v66
    v_fma_f32 v63, -v64, v31, -v67
    v_cvt_pk_bf16_f32 v163, v56, v57
    v_cvt_pk_bf16_f32 v171, v58, v59
    v_cvt_pk_bf16_f32 v179, v60, v61
    v_cvt_pk_bf16_f32 v187, v62, v63
    v_lshlrev_b32 v72, 16, v163
    v_and_b32 v73, 0xffff0000, v163
    v_lshlrev_b32 v74, 16, v171
    v_and_b32 v75, 0xffff0000, v171
    v_lshlrev_b32 v76, 16, v179
    v_and_b32 v77, 0xffff0000, v179
    v_lshlrev_b32 v78, 16, v187
    v_and_b32 v79, 0xffff0000, v187
    v_sub_f32 v72, v56, v72
    v_sub_f32 v73, v57, v73
    v_sub_f32 v74, v58, v74
    v_sub_f32 v75, v59, v75
    v_sub_f32 v76, v60, v76
    v_sub_f32 v77, v61, v77
    v_sub_f32 v78, v62, v78
    v_sub_f32 v79, v63, v79
    v_cvt_pk_bf16_f32 v167, v72, v73
    v_cvt_pk_bf16_f32 v175, v74, v75
    v_cvt_pk_bf16_f32 v183, v76, v77
    v_cvt_pk_bf16_f32 v191, v78, v79
    ds_read_b128 v[28:31], v19 offset:25408
    s_waitcnt lgkmcnt(1)
    v_mul_f32 v104, v24, v23
    v_mul_f32 v105, v25, v23
    v_mul_f32 v108, v24, v20
    v_mul_f32 v109, v25, v20
    v_mfma_f32_16x16x32_bf16 v[40:43], v[160:163], v[184:187], v[40:43]
    v_mul_f32 v112, v24, v21
    v_mul_f32 v113, v25, v21
    v_mul_f32 v116, v24, v22
    v_mul_f32 v117, v25, v22
    v_mfma_f32_16x16x32_bf16 v[44:47], v[168:171], v[184:187], v[44:47]
    v_exp_f32 v104, v104
    v_fract_f32 v105, v105
    v_exp_f32 v108, v108
    v_fract_f32 v109, v109
    v_mfma_f32_16x16x32_bf16 v[48:51], v[176:179], v[184:187], v[48:51]
    v_exp_f32 v112, v112
    v_fract_f32 v113, v113
    v_exp_f32 v116, v116
    v_fract_f32 v117, v117
    v_mfma_f32_16x16x32_bf16 v[40:43], v[160:163], v[188:191], v[40:43]
    v_cos_f32 v106, v105
    v_sin_f32 v107, v105
    v_cos_f32 v110, v109
    v_sin_f32 v111, v109
    v_mfma_f32_16x16x32_bf16 v[44:47], v[168:171], v[188:191], v[44:47]
    v_cos_f32 v114, v113
    v_sin_f32 v115, v113
    v_cos_f32 v118, v117
    v_sin_f32 v119, v117
    v_mfma_f32_16x16x32_bf16 v[48:51], v[176:179], v[188:191], v[48:51]
    v_mul_f32 v64, v104, v106
    v_mul_f32 v65, v104, v107
    v_mul_f32 v56, v108, v110
    v_mul_f32 v57, v108, v111
    v_mfma_f32_16x16x32_bf16 v[40:43], v[164:167], v[184:187], v[40:43]
    v_mul_f32 v58, v112, v114
    v_mul_f32 v59, v112, v115
    v_mul_f32 v60, v116, v118
    v_mul_f32 v61, v116, v119
    v_mfma_f32_16x16x32_bf16 v[44:47], v[172:175], v[184:187], v[44:47]
    v_mul_f32 v66, v65, v27
    v_mul_f32 v67, v65, v26
    v_fma_f32 v62, v64, v26, -v66
    v_fma_f32 v63, -v64, v27, -v67
    v_mfma_f32_16x16x32_bf16 v[48:51], v[180:183], v[184:187], v[48:51]
    v_cvt_pk_bf16_f32 v128, v56, v57
    v_cvt_pk_bf16_f32 v136, v58, v59
    v_cvt_pk_bf16_f32 v144, v60, v61
    v_cvt_pk_bf16_f32 v152, v62, v63
    v_lshlrev_b32 v72, 16, v128
    v_and_b32 v73, 0xffff0000, v128
    v_lshlrev_b32 v74, 16, v136
    v_and_b32 v75, 0xffff0000, v136
    v_lshlrev_b32 v76, 16, v144
    v_and_b32 v77, 0xffff0000, v144
    v_lshlrev_b32 v78, 16, v152
    v_and_b32 v79, 0xffff0000, v152
    v_sub_f32 v72, v56, v72
    v_sub_f32 v73, v57, v73
    v_sub_f32 v74, v58, v74
    v_sub_f32 v75, v59, v75
    v_sub_f32 v76, v60, v76
    v_sub_f32 v77, v61, v77
    v_sub_f32 v78, v62, v78
    v_sub_f32 v79, v63, v79
    v_cvt_pk_bf16_f32 v132, v72, v73
    v_cvt_pk_bf16_f32 v140, v74, v75
    v_cvt_pk_bf16_f32 v148, v76, v77
    v_cvt_pk_bf16_f32 v156, v78, v79
    ds_read_b128 v[24:27], v19 offset:25472
    s_waitcnt lgkmcnt(1)
    v_mul_f32 v104, v28, v23
    v_mul_f32 v105, v29, v23
    v_mul_f32 v108, v28, v20
    v_mul_f32 v109, v29, v20
    v_mul_f32 v112, v28, v21
    v_mul_f32 v113, v29, v21
    v_mul_f32 v116, v28, v22
    v_mul_f32 v117, v29, v22
    v_exp_f32 v104, v104
    v_fract_f32 v105, v105
    v_exp_f32 v108, v108
    v_fract_f32 v109, v109
    v_exp_f32 v112, v112
    v_fract_f32 v113, v113
    v_exp_f32 v116, v116
    v_fract_f32 v117, v117
    v_cos_f32 v106, v105
    v_sin_f32 v107, v105
    v_cos_f32 v110, v109
    v_sin_f32 v111, v109
    v_cos_f32 v114, v113
    v_sin_f32 v115, v113
    v_cos_f32 v118, v117
    v_sin_f32 v119, v117
    v_mul_f32 v64, v104, v106
    v_mul_f32 v65, v104, v107
    v_mul_f32 v56, v108, v110
    v_mul_f32 v57, v108, v111
    v_mul_f32 v58, v112, v114
    v_mul_f32 v59, v112, v115
    v_mul_f32 v60, v116, v118
    v_mul_f32 v61, v116, v119
    v_mul_f32 v66, v65, v31
    v_mul_f32 v67, v65, v30
    v_fma_f32 v62, v64, v30, -v66
    v_fma_f32 v63, -v64, v31, -v67
    v_cvt_pk_bf16_f32 v129, v56, v57
    v_cvt_pk_bf16_f32 v137, v58, v59
    v_cvt_pk_bf16_f32 v145, v60, v61
    v_cvt_pk_bf16_f32 v153, v62, v63
    v_lshlrev_b32 v72, 16, v129
    v_and_b32 v73, 0xffff0000, v129
    v_lshlrev_b32 v74, 16, v137
    v_and_b32 v75, 0xffff0000, v137
    v_lshlrev_b32 v76, 16, v145
    v_and_b32 v77, 0xffff0000, v145
    v_lshlrev_b32 v78, 16, v153
    v_and_b32 v79, 0xffff0000, v153
    v_sub_f32 v72, v56, v72
    v_sub_f32 v73, v57, v73
    v_sub_f32 v74, v58, v74
    v_sub_f32 v75, v59, v75
    v_sub_f32 v76, v60, v76
    v_sub_f32 v77, v61, v77
    v_sub_f32 v78, v62, v78
    v_sub_f32 v79, v63, v79
    v_cvt_pk_bf16_f32 v133, v72, v73
    v_cvt_pk_bf16_f32 v141, v74, v75
    v_cvt_pk_bf16_f32 v149, v76, v77
    v_cvt_pk_bf16_f32 v157, v78, v79
    ds_read_b128 v[28:31], v19 offset:25536
    s_waitcnt lgkmcnt(1)
    v_mul_f32 v104, v24, v23
    v_mul_f32 v105, v25, v23
    v_mul_f32 v108, v24, v20
    v_mul_f32 v109, v25, v20
    v_mul_f32 v112, v24, v21
    v_mul_f32 v113, v25, v21
    v_mul_f32 v116, v24, v22
    v_mul_f32 v117, v25, v22
    v_exp_f32 v104, v104
    v_fract_f32 v105, v105
    v_exp_f32 v108, v108
    v_fract_f32 v109, v109
    v_exp_f32 v112, v112
    v_fract_f32 v113, v113
    v_exp_f32 v116, v116
    v_fract_f32 v117, v117
    v_cos_f32 v106, v105
    v_sin_f32 v107, v105
    v_cos_f32 v110, v109
    v_sin_f32 v111, v109
    v_cos_f32 v114, v113
    v_sin_f32 v115, v113
    v_cos_f32 v118, v117
    v_sin_f32 v119, v117
    v_mul_f32 v64, v104, v106
    v_mul_f32 v65, v104, v107
    v_mul_f32 v56, v108, v110
    v_mul_f32 v57, v108, v111
    v_mul_f32 v58, v112, v114
    v_mul_f32 v59, v112, v115
    v_mul_f32 v60, v116, v118
    v_mul_f32 v61, v116, v119
    v_mul_f32 v66, v65, v27
    v_mul_f32 v67, v65, v26
    v_fma_f32 v62, v64, v26, -v66
    v_fma_f32 v63, -v64, v27, -v67
    v_cvt_pk_bf16_f32 v130, v56, v57
    v_cvt_pk_bf16_f32 v138, v58, v59
    v_cvt_pk_bf16_f32 v146, v60, v61
    v_cvt_pk_bf16_f32 v154, v62, v63
    v_lshlrev_b32 v72, 16, v130
    v_and_b32 v73, 0xffff0000, v130
    v_lshlrev_b32 v74, 16, v138
    v_and_b32 v75, 0xffff0000, v138
    v_lshlrev_b32 v76, 16, v146
    v_and_b32 v77, 0xffff0000, v146
    v_lshlrev_b32 v78, 16, v154
    v_and_b32 v79, 0xffff0000, v154
    v_sub_f32 v72, v56, v72
    v_sub_f32 v73, v57, v73
    v_sub_f32 v74, v58, v74
    v_sub_f32 v75, v59, v75
    v_sub_f32 v76, v60, v76
    v_sub_f32 v77, v61, v77
    v_sub_f32 v78, v62, v78
    v_sub_f32 v79, v63, v79
    v_cvt_pk_bf16_f32 v134, v72, v73
    v_cvt_pk_bf16_f32 v142, v74, v75
    v_cvt_pk_bf16_f32 v150, v76, v77
    v_cvt_pk_bf16_f32 v158, v78, v79
    ds_read_b128 v[24:27], v19 offset:25600
    s_waitcnt lgkmcnt(1)
    v_mul_f32 v104, v28, v23
    v_mul_f32 v105, v29, v23
    v_mul_f32 v108, v28, v20
    v_mul_f32 v109, v29, v20
    v_mul_f32 v112, v28, v21
    v_mul_f32 v113, v29, v21
    v_mul_f32 v116, v28, v22
    v_mul_f32 v117, v29, v22
    v_exp_f32 v104, v104
    v_fract_f32 v105, v105
    v_exp_f32 v108, v108
    v_fract_f32 v109, v109
    v_exp_f32 v112, v112
    v_fract_f32 v113, v113
    v_exp_f32 v116, v116
    v_fract_f32 v117, v117
    v_cos_f32 v106, v105
    v_sin_f32 v107, v105
    v_cos_f32 v110, v109
    v_sin_f32 v111, v109
    v_cos_f32 v114, v113
    v_sin_f32 v115, v113
    v_cos_f32 v118, v117
    v_sin_f32 v119, v117
    v_mul_f32 v64, v104, v106
    v_mul_f32 v65, v104, v107
    v_mul_f32 v56, v108, v110
    v_mul_f32 v57, v108, v111
    v_mul_f32 v58, v112, v114
    v_mul_f32 v59, v112, v115
    v_mul_f32 v60, v116, v118
    v_mul_f32 v61, v116, v119
    v_mul_f32 v66, v65, v31
    v_mul_f32 v67, v65, v30
    v_fma_f32 v62, v64, v30, -v66
    v_fma_f32 v63, -v64, v31, -v67
    v_cvt_pk_bf16_f32 v131, v56, v57
    v_cvt_pk_bf16_f32 v139, v58, v59
    v_cvt_pk_bf16_f32 v147, v60, v61
    v_cvt_pk_bf16_f32 v155, v62, v63
    v_lshlrev_b32 v72, 16, v131
    v_and_b32 v73, 0xffff0000, v131
    v_lshlrev_b32 v74, 16, v139
    v_and_b32 v75, 0xffff0000, v139
    v_lshlrev_b32 v76, 16, v147
    v_and_b32 v77, 0xffff0000, v147
    v_lshlrev_b32 v78, 16, v155
    v_and_b32 v79, 0xffff0000, v155
    v_sub_f32 v72, v56, v72
    v_sub_f32 v73, v57, v73
    v_sub_f32 v74, v58, v74
    v_sub_f32 v75, v59, v75
    v_sub_f32 v76, v60, v76
    v_sub_f32 v77, v61, v77
    v_sub_f32 v78, v62, v78
    v_sub_f32 v79, v63, v79
    v_cvt_pk_bf16_f32 v135, v72, v73
    v_cvt_pk_bf16_f32 v143, v74, v75
    v_cvt_pk_bf16_f32 v151, v76, v77
    v_cvt_pk_bf16_f32 v159, v78, v79
    s_cmp_eq_u32 s63, 1
    s_cbranch_scc1 L_ci_18
    buffer_load_dwordx2 v[250:251], v254, s[64:67], 0 offen sc0 sc1
L_ci_18:
    ds_read_b128 v[28:31], v19 offset:25664
    s_waitcnt lgkmcnt(1)
    v_mul_f32 v104, v24, v23
    v_mul_f32 v105, v25, v23
    v_mul_f32 v108, v24, v20
    v_mul_f32 v109, v25, v20
    v_mfma_f32_16x16x32_bf16 v[40:43], v[128:131], v[152:155], v[40:43]
    v_mul_f32 v112, v24, v21
    v_mul_f32 v113, v25, v21
    v_mul_f32 v116, v24, v22
    v_mul_f32 v117, v25, v22
    v_mfma_f32_16x16x32_bf16 v[44:47], v[136:139], v[152:155], v[44:47]
    v_exp_f32 v104, v104
    v_fract_f32 v105, v105
    v_exp_f32 v108, v108
    v_fract_f32 v109, v109
    v_mfma_f32_16x16x32_bf16 v[48:51], v[144:147], v[152:155], v[48:51]
    v_exp_f32 v112, v112
    v_fract_f32 v113, v113
    v_exp_f32 v116, v116
    v_fract_f32 v117, v117
    v_mfma_f32_16x16x32_bf16 v[40:43], v[128:131], v[156:159], v[40:43]
    v_cos_f32 v106, v105
    v_sin_f32 v107, v105
    v_cos_f32 v110, v109
    v_sin_f32 v111, v109
    v_mfma_f32_16x16x32_bf16 v[44:47], v[136:139], v[156:159], v[44:47]
    v_cos_f32 v114, v113
    v_sin_f32 v115, v113
    v_cos_f32 v118, v117
    v_sin_f32 v119, v117
    v_mfma_f32_16x16x32_bf16 v[48:51], v[144:147], v[156:159], v[48:51]
    v_mul_f32 v64, v104, v106
    v_mul_f32 v65, v104, v107
    v_mul_f32 v56, v108, v110
    v_mul_f32 v57, v108, v111
    v_mfma_f32_16x16x32_bf16 v[40:43], v[132:135], v[152:155], v[40:43]
    v_mul_f32 v58, v112, v114
    v_mul_f32 v59, v112, v115
    v_mul_f32 v60, v116, v118
    v_mul_f32 v61, v116, v119
    v_mfma_f32_16x16x32_bf16 v[44:47], v[140:143], v[152:155], v[44:47]
    v_mul_f32 v66, v65, v27
    v_mul_f32 v67, v65, v26
    v_fma_f32 v62, v64, v26, -v66
    v_fma_f32 v63, -v64, v27, -v67
    v_mfma_f32_16x16x32_bf16 v[48:51], v[148:151], v[152:155], v[48:51]
    v_cvt_pk_bf16_f32 v160, v56, v57
    v_cvt_pk_bf16_f32 v168, v58, v59
    v_cvt_pk_bf16_f32 v176, v60, v61
    v_cvt_pk_bf16_f32 v184, v62, v63
    v_lshlrev_b32 v72, 16, v160
    v_and_b32 v73, 0xffff0000, v160
    v_lshlrev_b32 v74, 16, v168
    v_and_b32 v75, 0xffff0000, v168
    v_lshlrev_b32 v76, 16, v176
    v_and_b32 v77, 0xffff0000, v176
    v_lshlrev_b32 v78, 16, v184
    v_and_b32 v79, 0xffff0000, v184
    v_sub_f32 v72, v56, v72
    v_sub_f32 v73, v57, v73
    v_sub_f32 v74, v58, v74
    v_sub_f32 v75, v59, v75
    v_sub_f32 v76, v60, v76
    v_sub_f32 v77, v61, v77
    v_sub_f32 v78, v62, v78
    v_sub_f32 v79, v63, v79
    v_cvt_pk_bf16_f32 v164, v72, v73
    v_cvt_pk_bf16_f32 v172, v74, v75
    v_cvt_pk_bf16_f32 v180, v76, v77
    v_cvt_pk_bf16_f32 v188, v78, v79
    ds_read_b128 v[24:27], v19 offset:25728
    s_waitcnt lgkmcnt(1)
    v_mul_f32 v104, v28, v23
    v_mul_f32 v105, v29, v23
    v_mul_f32 v108, v28, v20
    v_mul_f32 v109, v29, v20
    v_mul_f32 v112, v28, v21
    v_mul_f32 v113, v29, v21
    v_mul_f32 v116, v28, v22
    v_mul_f32 v117, v29, v22
    v_exp_f32 v104, v104
    v_fract_f32 v105, v105
    v_exp_f32 v108, v108
    v_fract_f32 v109, v109
    v_exp_f32 v112, v112
    v_fract_f32 v113, v113
    v_exp_f32 v116, v116
    v_fract_f32 v117, v117
    v_cos_f32 v106, v105
    v_sin_f32 v107, v105
    v_cos_f32 v110, v109
    v_sin_f32 v111, v109
    v_cos_f32 v114, v113
    v_sin_f32 v115, v113
    v_cos_f32 v118, v117
    v_sin_f32 v119, v117
    v_mul_f32 v64, v104, v106
    v_mul_f32 v65, v104, v107
    v_mul_f32 v56, v108, v110
    v_mul_f32 v57, v108, v111
    v_mul_f32 v58, v112, v114
    v_mul_f32 v59, v112, v115
    v_mul_f32 v60, v116, v118
    v_mul_f32 v61, v116, v119
    v_mul_f32 v66, v65, v31
    v_mul_f32 v67, v65, v30
    v_fma_f32 v62, v64, v30, -v66
    v_fma_f32 v63, -v64, v31, -v67
    v_cvt_pk_bf16_f32 v161, v56, v57
    v_cvt_pk_bf16_f32 v169, v58, v59
    v_cvt_pk_bf16_f32 v177, v60, v61
    v_cvt_pk_bf16_f32 v185, v62, v63
    v_lshlrev_b32 v72, 16, v161
    v_and_b32 v73, 0xffff0000, v161
    v_lshlrev_b32 v74, 16, v169
    v_and_b32 v75, 0xffff0000, v169
    v_lshlrev_b32 v76, 16, v177
    v_and_b32 v77, 0xffff0000, v177
    v_lshlrev_b32 v78, 16, v185
    v_and_b32 v79, 0xffff0000, v185
    v_sub_f32 v72, v56, v72
    v_sub_f32 v73, v57, v73
    v_sub_f32 v74, v58, v74
    v_sub_f32 v75, v59, v75
    v_sub_f32 v76, v60, v76
    v_sub_f32 v77, v61, v77
    v_sub_f32 v78, v62, v78
    v_sub_f32 v79, v63, v79
    v_cvt_pk_bf16_f32 v165, v72, v73
    v_cvt_pk_bf16_f32 v173, v74, v75
    v_cvt_pk_bf16_f32 v181, v76, v77
    v_cvt_pk_bf16_f32 v189, v78, v79
    ds_read_b128 v[28:31], v19 offset:25792
    s_waitcnt lgkmcnt(1)
    v_mul_f32 v104, v24, v23
    v_mul_f32 v105, v25, v23
    v_mul_f32 v108, v24, v20
    v_mul_f32 v109, v25, v20
    v_mul_f32 v112, v24, v21
    v_mul_f32 v113, v25, v21
    v_mul_f32 v116, v24, v22
    v_mul_f32 v117, v25, v22
    v_exp_f32 v104, v104
    v_fract_f32 v105, v105
    v_exp_f32 v108, v108
    v_fract_f32 v109, v109
    v_exp_f32 v112, v112
    v_fract_f32 v113, v113
    v_exp_f32 v116, v116
    v_fract_f32 v117, v117
    v_cos_f32 v106, v105
    v_sin_f32 v107, v105
    v_cos_f32 v110, v109
    v_sin_f32 v111, v109
    v_cos_f32 v114, v113
    v_sin_f32 v115, v113
    v_cos_f32 v118, v117
    v_sin_f32 v119, v117
    v_mul_f32 v64, v104, v106
    v_mul_f32 v65, v104, v107
    v_mul_f32 v56, v108, v110
    v_mul_f32 v57, v108, v111
    v_mul_f32 v58, v112, v114
    v_mul_f32 v59, v112, v115
    v_mul_f32 v60, v116, v118
    v_mul_f32 v61, v116, v119
    v_mul_f32 v66, v65, v27
    v_mul_f32 v67, v65, v26
    v_fma_f32 v62, v64, v26, -v66
    v_fma_f32 v63, -v64, v27, -v67
    v_cvt_pk_bf16_f32 v162, v56, v57
    v_cvt_pk_bf16_f32 v170, v58, v59
    v_cvt_pk_bf16_f32 v178, v60, v61
    v_cvt_pk_bf16_f32 v186, v62, v63
    v_lshlrev_b32 v72, 16, v162
    v_and_b32 v73, 0xffff0000, v162
    v_lshlrev_b32 v74, 16, v170
    v_and_b32 v75, 0xffff0000, v170
    v_lshlrev_b32 v76, 16, v178
    v_and_b32 v77, 0xffff0000, v178
    v_lshlrev_b32 v78, 16, v186
    v_and_b32 v79, 0xffff0000, v186
    v_sub_f32 v72, v56, v72
    v_sub_f32 v73, v57, v73
    v_sub_f32 v74, v58, v74
    v_sub_f32 v75, v59, v75
    v_sub_f32 v76, v60, v76
    v_sub_f32 v77, v61, v77
    v_sub_f32 v78, v62, v78
    v_sub_f32 v79, v63, v79
    v_cvt_pk_bf16_f32 v166, v72, v73
    v_cvt_pk_bf16_f32 v174, v74, v75
    v_cvt_pk_bf16_f32 v182, v76, v77
    v_cvt_pk_bf16_f32 v190, v78, v79
    s_waitcnt lgkmcnt(0)
    v_mul_f32 v104, v28, v23
    v_mul_f32 v105, v29, v23
    v_mul_f32 v108, v28, v20
    v_mul_f32 v109, v29, v20
    v_mul_f32 v112, v28, v21
    v_mul_f32 v113, v29, v21
    v_mul_f32 v116, v28, v22
    v_mul_f32 v117, v29, v22
    v_exp_f32 v104, v104
    v_fract_f32 v105, v105
    v_exp_f32 v108, v108
    v_fract_f32 v109, v109
    v_exp_f32 v112, v112
    v_fract_f32 v113, v113
    v_exp_f32 v116, v116
    v_fract_f32 v117, v117
    v_cos_f32 v106, v105
    v_sin_f32 v107, v105
    v_cos_f32 v110, v109
    v_sin_f32 v111, v109
    v_cos_f32 v114, v113
    v_sin_f32 v115, v113
    v_cos_f32 v118, v117
    v_sin_f32 v119, v117
    v_mul_f32 v64, v104, v106
    v_mul_f32 v65, v104, v107
    v_mul_f32 v56, v108, v110
    v_mul_f32 v57, v108, v111
    v_mul_f32 v58, v112, v114
    v_mul_f32 v59, v112, v115
    v_mul_f32 v60, v116, v118
    v_mul_f32 v61, v116, v119
    v_mul_f32 v66, v65, v31
    v_mul_f32 v67, v65, v30
    v_fma_f32 v62, v64, v30, -v66
    v_fma_f32 v63, -v64, v31, -v67
    v_cvt_pk_bf16_f32 v163, v56, v57
    v_cvt_pk_bf16_f32 v171, v58, v59
    v_cvt_pk_bf16_f32 v179, v60, v61
    v_cvt_pk_bf16_f32 v187, v62, v63
    v_lshlrev_b32 v72, 16, v163
    v_and_b32 v73, 0xffff0000, v163
    v_lshlrev_b32 v74, 16, v171
    v_and_b32 v75, 0xffff0000, v171
    v_lshlrev_b32 v76, 16, v179
    v_and_b32 v77, 0xffff0000, v179
    v_lshlrev_b32 v78, 16, v187
    v_and_b32 v79, 0xffff0000, v187
    v_sub_f32 v72, v56, v72
    v_sub_f32 v73, v57, v73
    v_sub_f32 v74, v58, v74
    v_sub_f32 v75, v59, v75
    v_sub_f32 v76, v60, v76
    v_sub_f32 v77, v61, v77
    v_sub_f32 v78, v62, v78
    v_sub_f32 v79, v63, v79
    v_cvt_pk_bf16_f32 v167, v72, v73
    v_cvt_pk_bf16_f32 v175, v74, v75
    v_cvt_pk_bf16_f32 v183, v76, v77
    v_cvt_pk_bf16_f32 v191, v78, v79
    s_nop 1
    v_mfma_f32_16x16x32_bf16 v[40:43], v[160:163], v[184:187], v[40:43]
    v_mfma_f32_16x16x32_bf16 v[44:47], v[168:171], v[184:187], v[44:47]
    v_mfma_f32_16x16x32_bf16 v[48:51], v[176:179], v[184:187], v[48:51]
    v_mfma_f32_16x16x32_bf16 v[40:43], v[160:163], v[188:191], v[40:43]
    v_mfma_f32_16x16x32_bf16 v[44:47], v[168:171], v[188:191], v[44:47]
    v_mfma_f32_16x16x32_bf16 v[48:51], v[176:179], v[188:191], v[48:51]
    v_mfma_f32_16x16x32_bf16 v[40:43], v[164:167], v[184:187], v[40:43]
    v_mfma_f32_16x16x32_bf16 v[44:47], v[172:175], v[184:187], v[44:47]
    v_mfma_f32_16x16x32_bf16 v[48:51], v[180:183], v[184:187], v[48:51]
    s_cmp_eq_u32 s63, 1
    s_cbranch_scc1 L_cc_19
    s_waitcnt vmcnt(0)
    s_memrealtime s[56:57]
    s_waitcnt lgkmcnt(0)
    s_add_u32 s56, s56, 128
    s_addc_u32 s57, s57, 0
    v_cmp_ge_u64 vcc, v[250:251], s[100:101]
    v_cmp_lt_u64 s[56:57], v[250:251], s[56:57]
    s_and_b64 s[56:57], s[56:57], vcc
    s_cmp_eq_u64 s[56:57], -1
    s_cbranch_scc0 L_cc_19
    s_mov_b32 s63, 1
L_cc_19:
    s_cmp_eq_u32 s63, 1
    s_cbranch_scc1 L_cr_20
    s_mov_b32 s62, 0
L_spin_21:
    buffer_load_dwordx2 v[250:251], v254, s[64:67], 0 offen sc0 sc1
    s_waitcnt vmcnt(0)
    s_memrealtime s[56:57]
    s_waitcnt lgkmcnt(0)
    s_add_u32 s56, s56, 128
    s_addc_u32 s57, s57, 0
    v_cmp_ge_u64 vcc, v[250:251], s[100:101]
    v_cmp_lt_u64 s[56:57], v[250:251], s[56:57]
    s_and_b64 s[56:57], s[56:57], vcc
    s_cmp_eq_u64 s[56:57], -1
    s_cbranch_scc1 L_ok_22
    s_sleep 4
    s_add_u32 s62, s62, 1
    s_cmp_lt_u32 s62, 4000
    s_cbranch_scc1 L_spin_21
    s_mov_b32 s60, 0
    s_movk_i32 s61, 2048
    s_mov_b32 s8, s44
    s_mov_b32 s9, s45
    s_mov_b32 s10, 2097152
    s_mov_b32 s11, 0x00020000
L_fb_23:
    v_and_b32 v129, 31, v0
    v_bfe_u32 v128, v0, 5, 1
    v_add_u32 v128, s60, v128
    v_lshlrev_b32 v130, 10, v128
    v_lshl_add_u32 v130, v129, 4, v130
    buffer_load_dwordx4 v[132:135], v130, s[8:11], 0 offen
    buffer_load_dwordx4 v[136:139], v130, s[8:11], 0 offen offset:512
    s_waitcnt vmcnt(0)
    v_lshlrev_b32 v140, 16, v132
    v_and_b32 v141, 0xffff0000, v132
    v_lshlrev_b32 v142, 16, v133
    v_and_b32 v143, 0xffff0000, v133
    v_lshlrev_b32 v144, 16, v134
    v_and_b32 v145, 0xffff0000, v134
    v_lshlrev_b32 v146, 16, v135
    v_and_b32 v147, 0xffff0000, v135
    v_lshlrev_b32 v148, 16, v136
    v_and_b32 v149, 0xffff0000, v136
    v_lshlrev_b32 v150, 16, v137
    v_and_b32 v151, 0xffff0000, v137
    v_lshlrev_b32 v152, 16, v138
    v_and_b32 v153, 0xffff0000, v138
    v_lshlrev_b32 v154, 16, v139
    v_and_b32 v155, 0xffff0000, v139
    v_add_f32 v156, v140, v141
    v_add_f32 v156, v156, v142
    v_add_f32 v156, v156, v143
    v_add_f32 v156, v156, v144
    v_add_f32 v156, v156, v145
    v_add_f32 v156, v156, v146
    v_add_f32 v156, v156, v147
    v_add_f32 v156, v156, v148
    v_add_f32 v156, v156, v149
    v_add_f32 v156, v156, v150
    v_add_f32 v156, v156, v151
    v_add_f32 v156, v156, v152
    v_add_f32 v156, v156, v153
    v_add_f32 v156, v156, v154
    v_add_f32 v156, v156, v155
    ds_swizzle_b32 v157, v156 offset:1055
    s_waitcnt lgkmcnt(0)
    v_add_f32 v156, v156, v157
    ds_swizzle_b32 v157, v156 offset:2079
    s_waitcnt lgkmcnt(0)
    v_add_f32 v156, v156, v157
    ds_swizzle_b32 v157, v156 offset:4127
    s_waitcnt lgkmcnt(0)
    v_add_f32 v156, v156, v157
    ds_swizzle_b32 v157, v156 offset:8223
    s_waitcnt lgkmcnt(0)
    v_add_f32 v156, v156, v157
    ds_swizzle_b32 v157, v156 offset:16415
    s_waitcnt lgkmcnt(0)
    v_add_f32 v156, v156, v157
    v_mul_f32 v156, 0x3b000000, v156
    v_sub_f32 v157, v140, v156
    v_mul_f32 v158, v157, v157
    v_sub_f32 v157, v141, v156
    v_fmac_f32 v158, v157, v157
    v_sub_f32 v157, v142, v156
    v_fmac_f32 v158, v157, v157
    v_sub_f32 v157, v143, v156
    v_fmac_f32 v158, v157, v157
    v_sub_f32 v157, v144, v156
    v_fmac_f32 v158, v157, v157
    v_sub_f32 v157, v145, v156
    v_fmac_f32 v158, v157, v157
    v_sub_f32 v157, v146, v156
    v_fmac_f32 v158, v157, v157
    v_sub_f32 v157, v147, v156
    v_fmac_f32 v158, v157, v157
    v_sub_f32 v157, v148, v156
    v_fmac_f32 v158, v157, v157
    v_sub_f32 v157, v149, v156
    v_fmac_f32 v158, v157, v157
    v_sub_f32 v157, v150, v156
    v_fmac_f32 v158, v157, v157
    v_sub_f32 v157, v151, v156
    v_fmac_f32 v158, v157, v157
    v_sub_f32 v157, v152, v156
    v_fmac_f32 v158, v157, v157
    v_sub_f32 v157, v153, v156
    v_fmac_f32 v158, v157, v157
    v_sub_f32 v157, v154, v156
    v_fmac_f32 v158, v157, v157
    v_sub_f32 v157, v155, v156
    v_fmac_f32 v158, v157, v157
    ds_swizzle_b32 v157, v158 offset:1055
    s_waitcnt lgkmcnt(0)
    v_add_f32 v158, v158, v157
    ds_swizzle_b32 v157, v158 offset:2079
    s_waitcnt lgkmcnt(0)
    v_add_f32 v158, v158, v157
    ds_swizzle_b32 v157, v158 offset:4127
    s_waitcnt lgkmcnt(0)
    v_add_f32 v158, v158, v157
    ds_swizzle_b32 v157, v158 offset:8223
    s_waitcnt lgkmcnt(0)
    v_add_f32 v158, v158, v157
    ds_swizzle_b32 v157, v158 offset:16415
    s_waitcnt lgkmcnt(0)
    v_add_f32 v158, v158, v157
    v_mul_f32 v158, 0x3b000000, v158
    v_cvt_pk_bf16_f32 v156, v156, v156
    v_lshlrev_b32 v156, 16, v156
    v_cvt_pk_bf16_f32 v158, v158, v158
    v_lshlrev_b32 v158, 16, v158
    v_add_f32 v158, 0x3727c5ac, v158
    v_cvt_pk_bf16_f32 v158, v158, v158
    v_lshlrev_b32 v158, 16, v158
    v_sqrt_f32 v158, v158
    s_nop 0
    v_cvt_pk_bf16_f32 v158, v158, v158
    v_lshlrev_b32 v158, 16, v158
    v_lshrrev_b32 v156, 16, v156
    v_or_b32 v156, v158, v156
    v_lshlrev_b32 v128, 2, v128
    v_cmp_eq_u32 vcc, 0, v129
    s_and_saveexec_b64 s[58:59], vcc
    buffer_store_dword v156, v128, s[64:67], 0 offen sc0 sc1
    s_mov_b64 exec, s[58:59]
    s_add_u32 s60, s60, 2
    s_cmp_lt_u32 s60, s61
    s_cbranch_scc1 L_fb_23
    s_mov_b32 s46, 0x05040100
    s_mov_b32 s47, 0x07060302
    s_lshl_b32 s60, s2, 2
    s_add_u32 s61, s60, 4096
    s_lshl_b32 s40, s2, 6
    v_add_u32 v128, 0, v12
    v_lshlrev_b32 v129, 13, v128
    buffer_load_dword v136, v129, s[8:11], s60 offen offset:0
    buffer_load_dword v137, v129, s[8:11], s60 offen offset:1024
    buffer_load_dword v138, v129, s[8:11], s60 offen offset:2048
    buffer_load_dword v139, v129, s[8:11], s60 offen offset:3072
    buffer_load_dword v140, v129, s[8:11], s61 offen offset:0
    buffer_load_dword v141, v129, s[8:11], s61 offen offset:1024
    buffer_load_dword v142, v129, s[8:11], s61 offen offset:2048
    buffer_load_dword v143, v129, s[8:11], s61 offen offset:3072
    v_lshrrev_b32 v130, 1, v128
    v_lshlrev_b32 v130, 14, v130
    v_and_b32 v131, 1, v128
    v_lshl_add_u32 v130, v131, 4, v130
    s_waitcnt vmcnt(0)
    v_perm_b32 v144, v137, v136, s46
    v_perm_b32 v148, v137, v136, s47
    v_perm_b32 v145, v139, v138, s46
    v_perm_b32 v149, v139, v138, s47
    v_perm_b32 v146, v141, v140, s46
    v_perm_b32 v150, v141, v140, s47
    v_perm_b32 v147, v143, v142, s46
    v_perm_b32 v151, v143, v142, s47
    buffer_store_dwordx4 v[144:147], v130, s[12:15], s40 offen sc0 sc1
    buffer_store_dwordx4 v[148:151], v130, s[12:15], s40 offen offset:32 sc0 sc1
    s_nop 1
    v_add_u32 v128, 64, v12
    v_lshlrev_b32 v129, 13, v128
    buffer_load_dword v136, v129, s[8:11], s60 offen offset:0
    buffer_load_dword v137, v129, s[8:11], s60 offen offset:1024
    buffer_load_dword v138, v129, s[8:11], s60 offen offset:2048
    buffer_load_dword v139, v129, s[8:11], s60 offen offset:3072
    buffer_load_dword v140, v129, s[8:11], s61 offen offset:0
    buffer_load_dword v141, v129, s[8:11], s61 offen offset:1024
    buffer_load_dword v142, v129, s[8:11], s61 offen offset:2048
    buffer_load_dword v143, v129, s[8:11], s61 offen offset:3072
    v_lshrrev_b32 v130, 1, v128
    v_lshlrev_b32 v130, 14, v130
    v_and_b32 v131, 1, v128
    v_lshl_add_u32 v130, v131, 4, v130
    s_waitcnt vmcnt(0)
    v_perm_b32 v144, v137, v136, s46
    v_perm_b32 v148, v137, v136, s47
    v_perm_b32 v145, v139, v138, s46
    v_perm_b32 v149, v139, v138, s47
    v_perm_b32 v146, v141, v140, s46
    v_perm_b32 v150, v141, v140, s47
    v_perm_b32 v147, v143, v142, s46
    v_perm_b32 v151, v143, v142, s47
    buffer_store_dwordx4 v[144:147], v130, s[12:15], s40 offen sc0 sc1
    buffer_store_dwordx4 v[148:151], v130, s[12:15], s40 offen offset:32 sc0 sc1
    s_nop 1
    v_add_u32 v128, 128, v12
    v_lshlrev_b32 v129, 13, v128
    buffer_load_dword v136, v129, s[8:11], s60 offen offset:0
    buffer_load_dword v137, v129, s[8:11], s60 offen offset:1024
    buffer_load_dword v138, v129, s[8:11], s60 offen offset:2048
    buffer_load_dword v139, v129, s[8:11], s60 offen offset:3072
    buffer_load_dword v140, v129, s[8:11], s61 offen offset:0
    buffer_load_dword v141, v129, s[8:11], s61 offen offset:1024
    buffer_load_dword v142, v129, s[8:11], s61 offen offset:2048
    buffer_load_dword v143, v129, s[8:11], s61 offen offset:3072
    v_lshrrev_b32 v130, 1, v128
    v_lshlrev_b32 v130, 14, v130
    v_and_b32 v131, 1, v128
    v_lshl_add_u32 v130, v131, 4, v130
    s_waitcnt vmcnt(0)
    v_perm_b32 v144, v137, v136, s46
    v_perm_b32 v148, v137, v136, s47
    v_perm_b32 v145, v139, v138, s46
    v_perm_b32 v149, v139, v138, s47
    v_perm_b32 v146, v141, v140, s46
    v_perm_b32 v150, v141, v140, s47
    v_perm_b32 v147, v143, v142, s46
    v_perm_b32 v151, v143, v142, s47
    buffer_store_dwordx4 v[144:147], v130, s[12:15], s40 offen sc0 sc1
    buffer_store_dwordx4 v[148:151], v130, s[12:15], s40 offen offset:32 sc0 sc1
    s_nop 1
    v_add_u32 v128, 192, v12
    v_lshlrev_b32 v129, 13, v128
    buffer_load_dword v136, v129, s[8:11], s60 offen offset:0
    buffer_load_dword v137, v129, s[8:11], s60 offen offset:1024
    buffer_load_dword v138, v129, s[8:11], s60 offen offset:2048
    buffer_load_dword v139, v129, s[8:11], s60 offen offset:3072
    buffer_load_dword v140, v129, s[8:11], s61 offen offset:0
    buffer_load_dword v141, v129, s[8:11], s61 offen offset:1024
    buffer_load_dword v142, v129, s[8:11], s61 offen offset:2048
    buffer_load_dword v143, v129, s[8:11], s61 offen offset:3072
    v_lshrrev_b32 v130, 1, v128
    v_lshlrev_b32 v130, 14, v130
    v_and_b32 v131, 1, v128
    v_lshl_add_u32 v130, v131, 4, v130
    s_waitcnt vmcnt(0)
    v_perm_b32 v144, v137, v136, s46
    v_perm_b32 v148, v137, v136, s47
    v_perm_b32 v145, v139, v138, s46
    v_perm_b32 v149, v139, v138, s47
    v_perm_b32 v146, v141, v140, s46
    v_perm_b32 v150, v141, v140, s47
    v_perm_b32 v147, v143, v142, s46
    v_perm_b32 v151, v143, v142, s47
    buffer_store_dwordx4 v[144:147], v130, s[12:15], s40 offen sc0 sc1
    buffer_store_dwordx4 v[148:151], v130, s[12:15], s40 offen offset:32 sc0 sc1
    s_nop 1
    s_waitcnt vmcnt(0)
L_ok_22:
L_cr_20:
    s_nop 7
    ds_write_b32 v216, v40 offset:16640
    ds_write_b32 v217, v48 offset:19200
    ds_write_b32 v218, v44 offset:16640
    ds_write_b32 v219, v41 offset:16640
    ds_write_b32 v220, v49 offset:19200
    ds_write_b32 v221, v45 offset:16640
    ds_write_b32 v222, v42 offset:16640
    ds_write_b32 v223, v50 offset:19200
    ds_write_b32 v224, v46 offset:16640
    ds_write_b32 v225, v43 offset:16640
    ds_write_b32 v226, v51 offset:19200
    ds_write_b32 v227, v47 offset:16640
    s_mov_b32 s58, 0
    s_mov_b32 s59, 1
    s_mov_b64 exec, s[58:59]
    ds_write_b32 v249, v44 offset:18176
    s_mov_b64 exec, 1
    ds_write_b32 v249, v48 offset:19200
    s_mov_b64 exec, -1
    s_waitcnt lgkmcnt(0)
    s_barrier
    s_lshl_b32 s27, s22, 5
    s_lshl_b32 s28, s21, 20
    s_add_u32 s27, s27, s28
    s_add_u32 s28, s27, 524288
    buffer_load_dwordx4 v[200:203], v253, s[12:15], s27 offen
    buffer_load_dwordx4 v[204:207], v253, s[12:15], s28 offen
    buffer_load_dwordx4 v[192:195], v252, s[64:67], 0 offen
    buffer_load_dwordx4 v[196:199], v252, s[64:67], 0 offen offset:16
    buffer_load_dwordx4 v[208:211], v252, s[64:67], 0 offen offset:2048
    buffer_load_dwordx4 v[212:215], v252, s[64:67], 0 offen offset:2064
    ds_read_b32 v24, v228 offset:16640
    ds_read_b32 v40, v228 offset:20736
    ds_read_b32 v25, v229 offset:16640
    ds_read_b32 v41, v229 offset:20736
    ds_read_b32 v26, v230 offset:16640
    ds_read_b32 v42, v230 offset:20736
    ds_read_b32 v27, v231 offset:16640
    ds_read_b32 v43, v231 offset:20736
    ds_read_b32 v28, v232 offset:16640
    ds_read_b32 v44, v232 offset:20736
    ds_read_b32 v29, v233 offset:16640
    ds_read_b32 v45, v233 offset:20736
    ds_read_b32 v30, v234 offset:16640
    ds_read_b32 v46, v234 offset:20736
    ds_read_b32 v31, v235 offset:16640
    ds_read_b32 v47, v235 offset:20736
    ds_read_b32 v32, v236 offset:16640
    ds_read_b32 v48, v236 offset:20736
    ds_read_b32 v33, v237 offset:16640
    ds_read_b32 v49, v237 offset:20736
    ds_read_b32 v34, v238 offset:16640
    ds_read_b32 v50, v238 offset:20736
    ds_read_b32 v35, v239 offset:16640
    ds_read_b32 v51, v239 offset:20736
    ds_read_b32 v36, v240 offset:16640
    ds_read_b32 v52, v240 offset:20736
    ds_read_b32 v37, v241 offset:16640
    ds_read_b32 v53, v241 offset:20736
    ds_read_b32 v38, v242 offset:16640
    ds_read_b32 v54, v242 offset:20736
    ds_read_b32 v39, v243 offset:16640
    ds_read_b32 v55, v243 offset:20736
    s_waitcnt lgkmcnt(15)
    v_add_f32 v24, v24, v40
    s_waitcnt lgkmcnt(15)
    v_add_f32 v25, v25, v41
    s_waitcnt lgkmcnt(15)
    v_add_f32 v26, v26, v42
    s_waitcnt lgkmcnt(15)
    v_add_f32 v27, v27, v43
    s_waitcnt lgkmcnt(15)
    v_add_f32 v28, v28, v44
    s_waitcnt lgkmcnt(15)
    v_add_f32 v29, v29, v45
    s_waitcnt lgkmcnt(15)
    v_add_f32 v30, v30, v46
    s_waitcnt lgkmcnt(15)
    v_add_f32 v31, v31, v47
    s_waitcnt lgkmcnt(14)
    v_add_f32 v32, v32, v48
    s_waitcnt lgkmcnt(12)
    v_add_f32 v33, v33, v49
    s_waitcnt lgkmcnt(10)
    v_add_f32 v34, v34, v50
    s_waitcnt lgkmcnt(8)
    v_add_f32 v35, v35, v51
    s_waitcnt lgkmcnt(6)
    v_add_f32 v36, v36, v52
    s_waitcnt lgkmcnt(4)
    v_add_f32 v37, v37, v53
    s_waitcnt lgkmcnt(2)
    v_add_f32 v38, v38, v54
    s_waitcnt lgkmcnt(0)
    v_add_f32 v39, v39, v55
    v_cvt_pk_bf16_f32 v56, v24, v25
    v_cvt_pk_bf16_f32 v57, v26, v27
    v_cvt_pk_bf16_f32 v58, v28, v29
    v_cvt_pk_bf16_f32 v59, v30, v31
    v_cvt_pk_bf16_f32 v60, v32, v33
    v_cvt_pk_bf16_f32 v61, v34, v35
    v_cvt_pk_bf16_f32 v62, v36, v37
    v_cvt_pk_bf16_f32 v63, v38, v39
    ds_write_b128 v244, v[56:59]
    ds_write_b128 v244, v[60:63] offset:16
    s_waitcnt lgkmcnt(0)
    s_barrier
    ds_read_b128 v[24:27], v245 offset:0
    ds_read_b128 v[28:31], v245 offset:16
    ds_read_b128 v[32:35], v245 offset:2048
    ds_read_b128 v[36:39], v245 offset:2064
    v_cmp_gt_u32 vcc, 16, v12
    s_and_saveexec_b64 s[58:59], vcc
    ds_write_b128 v124, v[120:123] offset:16640
    s_mov_b64 exec, s[58:59]
    s_waitcnt lgkmcnt(1)
    v_alignbit_b32 v60, v25, v24, 16
    v_alignbit_b32 v61, v26, v25, 16
    v_alignbit_b32 v62, v27, v26, 16
    v_alignbit_b32 v63, v28, v27, 16
    ds_write_b128 v245, v[60:63] offset:4160
    v_mov_b32 v64, v25
    v_mov_b32 v65, v26
    v_mov_b32 v66, v27
    v_mov_b32 v67, v28
    ds_write_b128 v245, v[64:67] offset:8320
    v_alignbit_b32 v68, v26, v25, 16
    v_alignbit_b32 v69, v27, v26, 16
    v_alignbit_b32 v70, v28, v27, 16
    v_alignbit_b32 v71, v29, v28, 16
    ds_write_b128 v245, v[68:71] offset:12480
    v_mov_b32 v72, v26
    v_mov_b32 v73, v27
    v_mov_b32 v74, v28
    v_mov_b32 v75, v29
    ds_write_b128 v245, v[72:75] offset:16640
    v_alignbit_b32 v76, v27, v26, 16
    v_alignbit_b32 v77, v28, v27, 16
    v_alignbit_b32 v78, v29, v28, 16
    v_alignbit_b32 v79, v30, v29, 16
    ds_write_b128 v245, v[76:79] offset:20800
    v_mov_b32 v80, v27
    v_mov_b32 v81, v28
    v_mov_b32 v82, v29
    v_mov_b32 v83, v30
    ds_write_b128 v245, v[80:83] offset:24960
    v_alignbit_b32 v84, v28, v27, 16
    v_alignbit_b32 v85, v29, v28, 16
    v_alignbit_b32 v86, v30, v29, 16
    v_alignbit_b32 v87, v31, v30, 16
    ds_write_b128 v245, v[84:87] offset:29120
    v_alignbit_b32 v56, v33, v32, 16
    v_alignbit_b32 v57, v34, v33, 16
    v_alignbit_b32 v58, v35, v34, 16
    v_alignbit_b32 v59, v36, v35, 16
    ds_write_b128 v245, v[56:59] offset:6208
    v_mov_b32 v60, v33
    v_mov_b32 v61, v34
    v_mov_b32 v62, v35
    v_mov_b32 v63, v36
    ds_write_b128 v245, v[60:63] offset:10368
    v_alignbit_b32 v64, v34, v33, 16
    v_alignbit_b32 v65, v35, v34, 16
    v_alignbit_b32 v66, v36, v35, 16
    v_alignbit_b32 v67, v37, v36, 16
    ds_write_b128 v245, v[64:67] offset:14528
    v_mov_b32 v68, v34
    v_mov_b32 v69, v35
    v_mov_b32 v70, v36
    v_mov_b32 v71, v37
    ds_write_b128 v245, v[68:71] offset:18688
    v_alignbit_b32 v72, v35, v34, 16
    v_alignbit_b32 v73, v36, v35, 16
    v_alignbit_b32 v74, v37, v36, 16
    v_alignbit_b32 v75, v38, v37, 16
    ds_write_b128 v245, v[72:75] offset:22848
    v_mov_b32 v76, v35
    v_mov_b32 v77, v36
    v_mov_b32 v78, v37
    v_mov_b32 v79, v38
    ds_write_b128 v245, v[76:79] offset:27008
    v_alignbit_b32 v80, v36, v35, 16
    v_alignbit_b32 v81, v37, v36, 16
    v_alignbit_b32 v82, v38, v37, 16
    v_alignbit_b32 v83, v39, v38, 16
    ds_write_b128 v245, v[80:83] offset:31168
    s_load_dwordx2 s[6:7], s[0:1], 88
    s_load_dwordx2 s[48:49], s[0:1], 80
    s_load_dwordx2 s[50:51], s[0:1], 0
    s_load_dwordx2 s[52:53], s[0:1], 96
    s_load_dwordx2 s[70:71], s[68:69], 0
    s_waitcnt vmcnt(0)
    s_waitcnt lgkmcnt(0)
    s_cmp_ge_u32 s2, 224
    s_cbranch_scc1 L_pfr_24
    s_mov_b32 s8, s48
    s_mov_b32 s9, s49
    s_mov_b32 s10, 1835008
    s_mov_b32 s11, 0x00020000
    s_lshr_b32 s40, s2, 3
    s_lshl_b32 s40, s40, 15
    v_lshlrev_b32 v255, 7, v0
    s_add_u32 s41, s40, 0
    s_lshr_b32 s42, s41, 16
    s_lshl_b32 s42, s42, 17
    s_and_b32 s41, s41, 0xffff
    s_add_u32 s41, s41, s42
    s_add_u32 s41, s41, 65536
    buffer_load_dword v254, v255, s[8:11], s41 offen
L_pfr_24:
    v_and_b32 v88, 0xffff0000, v192
    v_rcp_f32 v104, v88
    v_lshlrev_b32 v192, 16, v192
    v_and_b32 v89, 0xffff0000, v193
    v_rcp_f32 v105, v89
    v_lshlrev_b32 v193, 16, v193
    v_and_b32 v90, 0xffff0000, v194
    v_rcp_f32 v106, v90
    v_lshlrev_b32 v194, 16, v194
    v_and_b32 v91, 0xffff0000, v195
    v_rcp_f32 v107, v91
    v_lshlrev_b32 v195, 16, v195
    v_and_b32 v92, 0xffff0000, v196
    v_rcp_f32 v108, v92
    v_lshlrev_b32 v196, 16, v196
    v_and_b32 v93, 0xffff0000, v197
    v_rcp_f32 v109, v93
    v_lshlrev_b32 v197, 16, v197
    v_and_b32 v94, 0xffff0000, v198
    v_rcp_f32 v110, v94
    v_lshlrev_b32 v198, 16, v198
    v_and_b32 v95, 0xffff0000, v199
    v_rcp_f32 v111, v95
    v_lshlrev_b32 v199, 16, v199
    v_lshlrev_b32 v136, 16, v200
    v_and_b32 v137, 0xffff0000, v200
    v_lshlrev_b32 v138, 16, v201
    v_and_b32 v139, 0xffff0000, v201
    v_lshlrev_b32 v140, 16, v202
    v_and_b32 v141, 0xffff0000, v202
    v_lshlrev_b32 v142, 16, v203
    v_and_b32 v143, 0xffff0000, v203
    v_sub_f32 v136, v136, v192
    v_sub_f32 v137, v137, v193
    v_sub_f32 v138, v138, v194
    v_sub_f32 v139, v139, v195
    v_sub_f32 v140, v140, v196
    v_sub_f32 v141, v141, v197
    v_sub_f32 v142, v142, v198
    v_sub_f32 v143, v143, v199
    v_cvt_pk_bf16_f32 v152, v136, v137
    v_cvt_pk_bf16_f32 v153, v138, v139
    v_cvt_pk_bf16_f32 v154, v140, v141
    v_cvt_pk_bf16_f32 v155, v142, v143
    v_lshlrev_b32 v136, 16, v152
    v_and_b32 v137, 0xffff0000, v152
    v_lshlrev_b32 v138, 16, v153
    v_and_b32 v139, 0xffff0000, v153
    v_lshlrev_b32 v140, 16, v154
    v_and_b32 v141, 0xffff0000, v154
    v_lshlrev_b32 v142, 16, v155
    v_and_b32 v143, 0xffff0000, v155
    v_mul_f32 v152, v136, v104
    v_mul_f32 v153, v137, v105
    v_mul_f32 v154, v138, v106
    v_mul_f32 v155, v139, v107
    v_mul_f32 v156, v140, v108
    v_mul_f32 v157, v141, v109
    v_mul_f32 v158, v142, v110
    v_mul_f32 v159, v143, v111
    v_fma_f32 v168, -v152, v88, v136
    v_fma_f32 v169, -v153, v89, v137
    v_fma_f32 v170, -v154, v90, v138
    v_fma_f32 v171, -v155, v91, v139
    v_fma_f32 v172, -v156, v92, v140
    v_fma_f32 v173, -v157, v93, v141
    v_fma_f32 v174, -v158, v94, v142
    v_fma_f32 v175, -v159, v95, v143
    v_fma_f32 v136, v168, v104, v152
    v_fma_f32 v137, v169, v105, v153
    v_fma_f32 v138, v170, v106, v154
    v_fma_f32 v139, v171, v107, v155
    v_fma_f32 v140, v172, v108, v156
    v_fma_f32 v141, v173, v109, v157
    v_fma_f32 v142, v174, v110, v158
    v_fma_f32 v143, v175, v111, v159
    v_cvt_pk_bf16_f32 v152, v136, v137
    v_cvt_pk_bf16_f32 v153, v138, v139
    v_cvt_pk_bf16_f32 v154, v140, v141
    v_cvt_pk_bf16_f32 v155, v142, v143
    ds_write_b128 v248, v[152:155] offset:0
    v_and_b32 v96, 0xffff0000, v208
    v_rcp_f32 v112, v96
    v_lshlrev_b32 v208, 16, v208
    v_and_b32 v97, 0xffff0000, v209
    v_rcp_f32 v113, v97
    v_lshlrev_b32 v209, 16, v209
    v_and_b32 v98, 0xffff0000, v210
    v_rcp_f32 v114, v98
    v_lshlrev_b32 v210, 16, v210
    v_and_b32 v99, 0xffff0000, v211
    v_rcp_f32 v115, v99
    v_lshlrev_b32 v211, 16, v211
    v_and_b32 v100, 0xffff0000, v212
    v_rcp_f32 v116, v100
    v_lshlrev_b32 v212, 16, v212
    v_and_b32 v101, 0xffff0000, v213
    v_rcp_f32 v117, v101
    v_lshlrev_b32 v213, 16, v213
    v_and_b32 v102, 0xffff0000, v214
    v_rcp_f32 v118, v102
    v_lshlrev_b32 v214, 16, v214
    v_and_b32 v103, 0xffff0000, v215
    v_rcp_f32 v119, v103
    v_lshlrev_b32 v215, 16, v215
    v_lshlrev_b32 v144, 16, v204
    v_and_b32 v145, 0xffff0000, v204
    v_lshlrev_b32 v146, 16, v205
    v_and_b32 v147, 0xffff0000, v205
    v_lshlrev_b32 v148, 16, v206
    v_and_b32 v149, 0xffff0000, v206
    v_lshlrev_b32 v150, 16, v207
    v_and_b32 v151, 0xffff0000, v207
    v_sub_f32 v144, v144, v208
    v_sub_f32 v145, v145, v209
    v_sub_f32 v146, v146, v210
    v_sub_f32 v147, v147, v211
    v_sub_f32 v148, v148, v212
    v_sub_f32 v149, v149, v213
    v_sub_f32 v150, v150, v214
    v_sub_f32 v151, v151, v215
    v_cvt_pk_bf16_f32 v160, v144, v145
    v_cvt_pk_bf16_f32 v161, v146, v147
    v_cvt_pk_bf16_f32 v162, v148, v149
    v_cvt_pk_bf16_f32 v163, v150, v151
    v_lshlrev_b32 v144, 16, v160
    v_and_b32 v145, 0xffff0000, v160
    v_lshlrev_b32 v146, 16, v161
    v_and_b32 v147, 0xffff0000, v161
    v_lshlrev_b32 v148, 16, v162
    v_and_b32 v149, 0xffff0000, v162
    v_lshlrev_b32 v150, 16, v163
    v_and_b32 v151, 0xffff0000, v163
    v_mul_f32 v160, v144, v112
    v_mul_f32 v161, v145, v113
    v_mul_f32 v162, v146, v114
    v_mul_f32 v163, v147, v115
    v_mul_f32 v164, v148, v116
    v_mul_f32 v165, v149, v117
    v_mul_f32 v166, v150, v118
    v_mul_f32 v167, v151, v119
    v_fma_f32 v176, -v160, v96, v144
    v_fma_f32 v177, -v161, v97, v145
    v_fma_f32 v178, -v162, v98, v146
    v_fma_f32 v179, -v163, v99, v147
    v_fma_f32 v180, -v164, v100, v148
    v_fma_f32 v181, -v165, v101, v149
    v_fma_f32 v182, -v166, v102, v150
    v_fma_f32 v183, -v167, v103, v151
    v_fma_f32 v144, v176, v112, v160
    v_fma_f32 v145, v177, v113, v161
    v_fma_f32 v146, v178, v114, v162
    v_fma_f32 v147, v179, v115, v163
    v_fma_f32 v148, v180, v116, v164
    v_fma_f32 v149, v181, v117, v165
    v_fma_f32 v150, v182, v118, v166
    v_fma_f32 v151, v183, v119, v167
    v_cvt_pk_bf16_f32 v160, v144, v145
    v_cvt_pk_bf16_f32 v161, v146, v147
    v_cvt_pk_bf16_f32 v162, v148, v149
    v_cvt_pk_bf16_f32 v163, v150, v151
    ds_write_b128 v248, v[160:163] offset:1280
    v_mov_b32 v16, v246
    v_mov_b32 v17, v247
    s_waitcnt lgkmcnt(0)
    s_barrier
    v_lshlrev_b32 v3, 4, v12
    ds_read_b128 v[20:23], v16 offset:4080
    ds_read_b128 v[24:27], v17 offset:5120
    ds_read_b128 v[28:31], v17 offset:2560
    ds_read_b128 v[32:35], v16 offset:4016
    ds_read_b128 v[36:39], v17 offset:5040
    ds_read_b128 v[40:43], v17 offset:2480
    ds_read_b128 v[44:47], v16 offset:3952
    ds_read_b128 v[48:51], v17 offset:4960
    ds_read_b128 v[52:55], v17 offset:2400
    s_waitcnt lgkmcnt(6)
    v_mfma_f32_32x32x16_bf16 v[80:95], v[20:23], v[24:27], 0
    v_mfma_f32_32x32x16_bf16 v[64:79], v[20:23], v[28:31], 0
    ds_read_b128 v[20:23], v16 offset:3888
    ds_read_b128 v[24:27], v17 offset:4880
    ds_read_b128 v[28:31], v17 offset:2320
    s_waitcnt lgkmcnt(6)
    v_mfma_f32_32x32x16_bf16 v[80:95], v[32:35], v[36:39], v[80:95]
    v_mfma_f32_32x32x16_bf16 v[64:79], v[32:35], v[40:43], v[64:79]
    ds_read_b128 v[32:35], v16 offset:3824
    ds_read_b128 v[36:39], v17 offset:4800
    ds_read_b128 v[40:43], v17 offset:2240
    s_waitcnt lgkmcnt(6)
    v_mfma_f32_32x32x16_bf16 v[80:95], v[44:47], v[48:51], v[80:95]
    v_mfma_f32_32x32x16_bf16 v[64:79], v[44:47], v[52:55], v[64:79]
    ds_read_b128 v[44:47], v16 offset:3760
    ds_read_b128 v[48:51], v17 offset:4720
    ds_read_b128 v[52:55], v17 offset:2160
    s_waitcnt lgkmcnt(6)
    v_mfma_f32_32x32x16_bf16 v[80:95], v[20:23], v[24:27], v[80:95]
    v_mfma_f32_32x32x16_bf16 v[64:79], v[20:23], v[28:31], v[64:79]
    ds_read_b128 v[20:23], v16 offset:3696
    ds_read_b128 v[24:27], v17 offset:4640
    ds_read_b128 v[28:31], v17 offset:2080
    s_waitcnt lgkmcnt(6)
    v_mfma_f32_32x32x16_bf16 v[80:95], v[32:35], v[36:39], v[80:95]
    v_mfma_f32_32x32x16_bf16 v[64:79], v[32:35], v[40:43], v[64:79]
    ds_read_b128 v[32:35], v16 offset:3632
    ds_read_b128 v[36:39], v17 offset:4560
    ds_read_b128 v[40:43], v17 offset:2000
    s_waitcnt lgkmcnt(6)
    v_mfma_f32_32x32x16_bf16 v[80:95], v[44:47], v[48:51], v[80:95]
    v_mfma_f32_32x32x16_bf16 v[64:79], v[44:47], v[52:55], v[64:79]
    ds_read_b128 v[44:47], v16 offset:3568
    ds_read_b128 v[48:51], v17 offset:4480
    ds_read_b128 v[52:55], v17 offset:1920
    s_waitcnt lgkmcnt(6)
    v_mfma_f32_32x32x16_bf16 v[80:95], v[20:23], v[24:27], v[80:95]
    v_mfma_f32_32x32x16_bf16 v[64:79], v[20:23], v[28:31], v[64:79]
    ds_read_b128 v[20:23], v16 offset:3504
    ds_read_b128 v[24:27], v17 offset:4400
    ds_read_b128 v[28:31], v17 offset:1840
    s_waitcnt lgkmcnt(6)
    v_mfma_f32_32x32x16_bf16 v[80:95], v[32:35], v[36:39], v[80:95]
    v_mfma_f32_32x32x16_bf16 v[64:79], v[32:35], v[40:43], v[64:79]
    ds_read_b128 v[32:35], v16 offset:3440
    ds_read_b128 v[36:39], v17 offset:4320
    ds_read_b128 v[40:43], v17 offset:1760
    s_waitcnt lgkmcnt(6)
    v_mfma_f32_32x32x16_bf16 v[80:95], v[44:47], v[48:51], v[80:95]
    v_mfma_f32_32x32x16_bf16 v[64:79], v[44:47], v[52:55], v[64:79]
    ds_read_b128 v[44:47], v16 offset:3376
    ds_read_b128 v[48:51], v17 offset:4240
    ds_read_b128 v[52:55], v17 offset:1680
    s_waitcnt lgkmcnt(6)
    v_mfma_f32_32x32x16_bf16 v[80:95], v[20:23], v[24:27], v[80:95]
    v_mfma_f32_32x32x16_bf16 v[64:79], v[20:23], v[28:31], v[64:79]
    ds_read_b128 v[20:23], v16 offset:3312
    ds_read_b128 v[24:27], v17 offset:4160
    ds_read_b128 v[28:31], v17 offset:1600
    s_waitcnt lgkmcnt(6)
    v_mfma_f32_32x32x16_bf16 v[80:95], v[32:35], v[36:39], v[80:95]
    v_mfma_f32_32x32x16_bf16 v[64:79], v[32:35], v[40:43], v[64:79]
    ds_read_b128 v[32:35], v16 offset:3248
    ds_read_b128 v[36:39], v17 offset:4080
    ds_read_b128 v[40:43], v17 offset:1520
    s_waitcnt lgkmcnt(6)
    v_mfma_f32_32x32x16_bf16 v[80:95], v[44:47], v[48:51], v[80:95]
    v_mfma_f32_32x32x16_bf16 v[64:79], v[44:47], v[52:55], v[64:79]
    ds_read_b128 v[44:47], v16 offset:3184
    ds_read_b128 v[48:51], v17 offset:4000
    ds_read_b128 v[52:55], v17 offset:1440
    s_waitcnt lgkmcnt(6)
    v_mfma_f32_32x32x16_bf16 v[80:95], v[20:23], v[24:27], v[80:95]
    v_mfma_f32_32x32x16_bf16 v[64:79], v[20:23], v[28:31], v[64:79]
    ds_read_b128 v[20:23], v16 offset:3120
    ds_read_b128 v[24:27], v17 offset:3920
    ds_read_b128 v[28:31], v17 offset:1360
    s_waitcnt lgkmcnt(6)
    v_mfma_f32_32x32x16_bf16 v[80:95], v[32:35], v[36:39], v[80:95]
    v_mfma_f32_32x32x16_bf16 v[64:79], v[32:35], v[40:43], v[64:79]
    ds_read_b128 v[32:35], v16 offset:3056
    ds_read_b128 v[36:39], v17 offset:3840
    ds_read_b128 v[40:43], v17 offset:1280
    s_waitcnt lgkmcnt(6)
    v_mfma_f32_32x32x16_bf16 v[80:95], v[44:47], v[48:51], v[80:95]
    v_mfma_f32_32x32x16_bf16 v[64:79], v[44:47], v[52:55], v[64:79]
    ds_read_b128 v[44:47], v16 offset:2992
    ds_read_b128 v[48:51], v17 offset:3760
    ds_read_b128 v[52:55], v17 offset:1200
    s_waitcnt lgkmcnt(6)
    v_mfma_f32_32x32x16_bf16 v[80:95], v[20:23], v[24:27], v[80:95]
    v_mfma_f32_32x32x16_bf16 v[64:79], v[20:23], v[28:31], v[64:79]
    ds_read_b128 v[20:23], v16 offset:2928
    ds_read_b128 v[24:27], v17 offset:3680
    ds_read_b128 v[28:31], v17 offset:1120
    s_waitcnt lgkmcnt(6)
    v_mfma_f32_32x32x16_bf16 v[80:95], v[32:35], v[36:39], v[80:95]
    v_mfma_f32_32x32x16_bf16 v[64:79], v[32:35], v[40:43], v[64:79]
    ds_read_b128 v[32:35], v16 offset:2864
    ds_read_b128 v[36:39], v17 offset:3600
    ds_read_b128 v[40:43], v17 offset:1040
    s_waitcnt lgkmcnt(6)
    v_mfma_f32_32x32x16_bf16 v[80:95], v[44:47], v[48:51], v[80:95]
    v_mfma_f32_32x32x16_bf16 v[64:79], v[44:47], v[52:55], v[64:79]
    ds_read_b128 v[44:47], v16 offset:2800
    ds_read_b128 v[48:51], v17 offset:3520
    ds_read_b128 v[52:55], v17 offset:960
    s_waitcnt lgkmcnt(6)
    v_mfma_f32_32x32x16_bf16 v[80:95], v[20:23], v[24:27], v[80:95]
    v_mfma_f32_32x32x16_bf16 v[64:79], v[20:23], v[28:31], v[64:79]
    ds_read_b128 v[20:23], v16 offset:2736
    ds_read_b128 v[24:27], v17 offset:3440
    ds_read_b128 v[28:31], v17 offset:880
    s_waitcnt lgkmcnt(6)
    v_mfma_f32_32x32x16_bf16 v[80:95], v[32:35], v[36:39], v[80:95]
    v_mfma_f32_32x32x16_bf16 v[64:79], v[32:35], v[40:43], v[64:79]
    ds_read_b128 v[32:35], v16 offset:2672
    ds_read_b128 v[36:39], v17 offset:3360
    ds_read_b128 v[40:43], v17 offset:800
    s_waitcnt lgkmcnt(6)
    v_mfma_f32_32x32x16_bf16 v[80:95], v[44:47], v[48:51], v[80:95]
    v_mfma_f32_32x32x16_bf16 v[64:79], v[44:47], v[52:55], v[64:79]
    ds_read_b128 v[44:47], v16 offset:2608
    ds_read_b128 v[48:51], v17 offset:3280
    ds_read_b128 v[52:55], v17 offset:720
    s_waitcnt lgkmcnt(6)
    v_mfma_f32_32x32x16_bf16 v[80:95], v[20:23], v[24:27], v[80:95]
    v_mfma_f32_32x32x16_bf16 v[64:79], v[20:23], v[28:31], v[64:79]
    ds_read_b128 v[20:23], v16 offset:2544
    ds_read_b128 v[24:27], v17 offset:3200
    ds_read_b128 v[28:31], v17 offset:640
    s_waitcnt lgkmcnt(6)
    v_mfma_f32_32x32x16_bf16 v[80:95], v[32:35], v[36:39], v[80:95]
    v_mfma_f32_32x32x16_bf16 v[64:79], v[32:35], v[40:43], v[64:79]
    ds_read_b128 v[32:35], v16 offset:2480
    ds_read_b128 v[36:39], v17 offset:3120
    ds_read_b128 v[40:43], v17 offset:560
    s_waitcnt lgkmcnt(6)
    v_mfma_f32_32x32x16_bf16 v[80:95], v[44:47], v[48:51], v[80:95]
    v_mfma_f32_32x32x16_bf16 v[64:79], v[44:47], v[52:55], v[64:79]
    ds_read_b128 v[44:47], v16 offset:2416
    ds_read_b128 v[48:51], v17 offset:3040
    ds_read_b128 v[52:55], v17 offset:480
    s_waitcnt lgkmcnt(6)
    v_mfma_f32_32x32x16_bf16 v[80:95], v[20:23], v[24:27], v[80:95]
    v_mfma_f32_32x32x16_bf16 v[64:79], v[20:23], v[28:31], v[64:79]
    ds_read_b128 v[20:23], v16 offset:2352
    ds_read_b128 v[24:27], v17 offset:2960
    ds_read_b128 v[28:31], v17 offset:400
    s_waitcnt lgkmcnt(6)
    v_mfma_f32_32x32x16_bf16 v[80:95], v[32:35], v[36:39], v[80:95]
    v_mfma_f32_32x32x16_bf16 v[64:79], v[32:35], v[40:43], v[64:79]
    ds_read_b128 v[32:35], v16 offset:2288
    ds_read_b128 v[36:39], v17 offset:2880
    ds_read_b128 v[40:43], v17 offset:320
    s_waitcnt lgkmcnt(6)
    v_mfma_f32_32x32x16_bf16 v[80:95], v[44:47], v[48:51], v[80:95]
    v_mfma_f32_32x32x16_bf16 v[64:79], v[44:47], v[52:55], v[64:79]
    ds_read_b128 v[44:47], v16 offset:2224
    ds_read_b128 v[48:51], v17 offset:2800
    ds_read_b128 v[52:55], v17 offset:240
    s_waitcnt lgkmcnt(6)
    v_mfma_f32_32x32x16_bf16 v[80:95], v[20:23], v[24:27], v[80:95]
    v_mfma_f32_32x32x16_bf16 v[64:79], v[20:23], v[28:31], v[64:79]
    ds_read_b128 v[20:23], v16 offset:2160
    ds_read_b128 v[24:27], v17 offset:2720
    ds_read_b128 v[28:31], v17 offset:160
    s_waitcnt lgkmcnt(6)
    v_mfma_f32_32x32x16_bf16 v[80:95], v[32:35], v[36:39], v[80:95]
    v_mfma_f32_32x32x16_bf16 v[64:79], v[32:35], v[40:43], v[64:79]
    ds_read_b128 v[32:35], v16 offset:2096
    ds_read_b128 v[36:39], v17 offset:2640
    ds_read_b128 v[40:43], v17 offset:80
    s_waitcnt lgkmcnt(6)
    v_mfma_f32_32x32x16_bf16 v[80:95], v[44:47], v[48:51], v[80:95]
    v_mfma_f32_32x32x16_bf16 v[64:79], v[44:47], v[52:55], v[64:79]
    ds_read_b128 v[44:47], v16 offset:2032
    ds_read_b128 v[48:51], v17 offset:2560
    s_waitcnt lgkmcnt(5)
    v_mfma_f32_32x32x16_bf16 v[80:95], v[20:23], v[24:27], v[80:95]
    v_mfma_f32_32x32x16_bf16 v[64:79], v[20:23], v[28:31], v[64:79]
    ds_read_b128 v[20:23], v16 offset:1968
    ds_read_b128 v[24:27], v17 offset:2480
    s_waitcnt lgkmcnt(4)
    v_mfma_f32_32x32x16_bf16 v[80:95], v[32:35], v[36:39], v[80:95]
    v_mfma_f32_32x32x16_bf16 v[64:79], v[32:35], v[40:43], v[64:79]
    ds_read_b128 v[32:35], v16 offset:1904
    ds_read_b128 v[36:39], v17 offset:2400
    s_waitcnt lgkmcnt(4)
    v_mfma_f32_32x32x16_bf16 v[80:95], v[44:47], v[48:51], v[80:95]
    ds_read_b128 v[44:47], v16 offset:1840
    ds_read_b128 v[48:51], v17 offset:2320
    s_waitcnt lgkmcnt(4)
    v_mfma_f32_32x32x16_bf16 v[80:95], v[20:23], v[24:27], v[80:95]
    ds_read_b128 v[20:23], v16 offset:1776
    ds_read_b128 v[24:27], v17 offset:2240
    s_waitcnt lgkmcnt(4)
    v_mfma_f32_32x32x16_bf16 v[80:95], v[32:35], v[36:39], v[80:95]
    ds_read_b128 v[32:35], v16 offset:1712
    ds_read_b128 v[36:39], v17 offset:2160
    s_waitcnt lgkmcnt(4)
    v_mfma_f32_32x32x16_bf16 v[80:95], v[44:47], v[48:51], v[80:95]
    ds_read_b128 v[44:47], v16 offset:1648
    ds_read_b128 v[48:51], v17 offset:2080
    s_waitcnt lgkmcnt(4)
    v_mfma_f32_32x32x16_bf16 v[80:95], v[20:23], v[24:27], v[80:95]
    ds_read_b128 v[20:23], v16 offset:1584
    ds_read_b128 v[24:27], v17 offset:2000
    s_waitcnt lgkmcnt(4)
    v_mfma_f32_32x32x16_bf16 v[80:95], v[32:35], v[36:39], v[80:95]
    ds_read_b128 v[32:35], v16 offset:1520
    ds_read_b128 v[36:39], v17 offset:1920
    s_waitcnt lgkmcnt(4)
    v_mfma_f32_32x32x16_bf16 v[80:95], v[44:47], v[48:51], v[80:95]
    ds_read_b128 v[44:47], v16 offset:1456
    ds_read_b128 v[48:51], v17 offset:1840
    s_waitcnt lgkmcnt(4)
    v_mfma_f32_32x32x16_bf16 v[80:95], v[20:23], v[24:27], v[80:95]
    ds_read_b128 v[20:23], v16 offset:1392
    ds_read_b128 v[24:27], v17 offset:1760
    s_waitcnt lgkmcnt(4)
    v_mfma_f32_32x32x16_bf16 v[80:95], v[32:35], v[36:39], v[80:95]
    ds_read_b128 v[32:35], v16 offset:1328
    ds_read_b128 v[36:39], v17 offset:1680
    s_waitcnt lgkmcnt(4)
    v_mfma_f32_32x32x16_bf16 v[80:95], v[44:47], v[48:51], v[80:95]
    ds_read_b128 v[44:47], v16 offset:1264
    ds_read_b128 v[48:51], v17 offset:1600
    s_waitcnt lgkmcnt(4)
    v_mfma_f32_32x32x16_bf16 v[80:95], v[20:23], v[24:27], v[80:95]
    ds_read_b128 v[20:23], v16 offset:1200
    ds_read_b128 v[24:27], v17 offset:1520
    s_waitcnt lgkmcnt(4)
    v_mfma_f32_32x32x16_bf16 v[80:95], v[32:35], v[36:39], v[80:95]
    ds_read_b128 v[32:35], v16 offset:1136
    ds_read_b128 v[36:39], v17 offset:1440
    s_waitcnt lgkmcnt(4)
    v_mfma_f32_32x32x16_bf16 v[80:95], v[44:47], v[48:51], v[80:95]
    ds_read_b128 v[44:47], v16 offset:1072
    ds_read_b128 v[48:51], v17 offset:1360
    s_waitcnt lgkmcnt(4)
    v_mfma_f32_32x32x16_bf16 v[80:95], v[20:23], v[24:27], v[80:95]
    ds_read_b128 v[20:23], v16 offset:1008
    ds_read_b128 v[24:27], v17 offset:1280
    s_waitcnt lgkmcnt(4)
    v_mfma_f32_32x32x16_bf16 v[80:95], v[32:35], v[36:39], v[80:95]
    ds_read_b128 v[32:35], v16 offset:944
    ds_read_b128 v[36:39], v17 offset:1200
    s_waitcnt lgkmcnt(4)
    v_mfma_f32_32x32x16_bf16 v[80:95], v[44:47], v[48:51], v[80:95]
    ds_read_b128 v[44:47], v16 offset:880
    ds_read_b128 v[48:51], v17 offset:1120
    s_waitcnt lgkmcnt(4)
    v_mfma_f32_32x32x16_bf16 v[80:95], v[20:23], v[24:27], v[80:95]
    ds_read_b128 v[20:23], v16 offset:816
    ds_read_b128 v[24:27], v17 offset:1040
    s_waitcnt lgkmcnt(4)
    v_mfma_f32_32x32x16_bf16 v[80:95], v[32:35], v[36:39], v[80:95]
    ds_read_b128 v[32:35], v16 offset:752
    ds_read_b128 v[36:39], v17 offset:960
    s_waitcnt lgkmcnt(4)
    v_mfma_f32_32x32x16_bf16 v[80:95], v[44:47], v[48:51], v[80:95]
    ds_read_b128 v[44:47], v16 offset:688
    ds_read_b128 v[48:51], v17 offset:880
    s_waitcnt lgkmcnt(4)
    v_mfma_f32_32x32x16_bf16 v[80:95], v[20:23], v[24:27], v[80:95]
    ds_read_b128 v[20:23], v16 offset:624
    ds_read_b128 v[24:27], v17 offset:800
    s_waitcnt lgkmcnt(4)
    v_mfma_f32_32x32x16_bf16 v[80:95], v[32:35], v[36:39], v[80:95]
    ds_read_b128 v[32:35], v16 offset:560
    ds_read_b128 v[36:39], v17 offset:720
    s_waitcnt lgkmcnt(4)
    v_mfma_f32_32x32x16_bf16 v[80:95], v[44:47], v[48:51], v[80:95]
    ds_read_b128 v[44:47], v16 offset:496
    ds_read_b128 v[48:51], v17 offset:640
    s_waitcnt lgkmcnt(4)
    v_mfma_f32_32x32x16_bf16 v[80:95], v[20:23], v[24:27], v[80:95]
    ds_read_b128 v[20:23], v16 offset:432
    ds_read_b128 v[24:27], v17 offset:560
    s_waitcnt lgkmcnt(4)
    v_mfma_f32_32x32x16_bf16 v[80:95], v[32:35], v[36:39], v[80:95]
    ds_read_b128 v[32:35], v16 offset:368
    ds_read_b128 v[36:39], v17 offset:480
    s_waitcnt lgkmcnt(4)
    v_mfma_f32_32x32x16_bf16 v[80:95], v[44:47], v[48:51], v[80:95]
    ds_read_b128 v[44:47], v16 offset:304
    ds_read_b128 v[48:51], v17 offset:400
    s_waitcnt lgkmcnt(4)
    v_mfma_f32_32x32x16_bf16 v[80:95], v[20:23], v[24:27], v[80:95]
    ds_read_b128 v[20:23], v16 offset:240
    ds_read_b128 v[24:27], v17 offset:320
    s_waitcnt lgkmcnt(4)
    v_mfma_f32_32x32x16_bf16 v[80:95], v[32:35], v[36:39], v[80:95]
    ds_read_b128 v[32:35], v16 offset:176
    ds_read_b128 v[36:39], v17 offset:240
    s_waitcnt lgkmcnt(4)
    v_mfma_f32_32x32x16_bf16 v[80:95], v[44:47], v[48:51], v[80:95]
    ds_read_b128 v[44:47], v16 offset:112
    ds_read_b128 v[48:51], v17 offset:160
    s_waitcnt lgkmcnt(4)
    v_mfma_f32_32x32x16_bf16 v[80:95], v[20:23], v[24:27], v[80:95]
    ds_read_b128 v[20:23], v16 offset:48
    ds_read_b128 v[24:27], v17 offset:80
    s_waitcnt lgkmcnt(4)
    v_mfma_f32_32x32x16_bf16 v[80:95], v[32:35], v[36:39], v[80:95]
    s_waitcnt lgkmcnt(2)
    v_mfma_f32_32x32x16_bf16 v[80:95], v[44:47], v[48:51], v[80:95]
    s_waitcnt lgkmcnt(0)
    v_mfma_f32_32x32x16_bf16 v[80:95], v[20:23], v[24:27], v[80:95]
    s_nop 15
    s_nop 3
    s_barrier
    s_lshl_b32 s27, s21, 12
    s_add_u32 s27, s27, s25
    v_add_u32 v4, s27, v3
    s_cmp_eq_u32 s21, 0
    s_cbranch_scc0 L_cx1
    ds_write_b128 v4, v[80:83] offset:0
    ds_write_b128 v4, v[84:87] offset:1024
    ds_write_b128 v4, v[88:91] offset:2048
    ds_write_b128 v4, v[92:95] offset:3072
    s_branch L_cx2
L_cx1:
    ds_write_b128 v4, v[64:67] offset:0
    ds_write_b128 v4, v[68:71] offset:1024
    ds_write_b128 v4, v[72:75] offset:2048
    ds_write_b128 v4, v[76:79] offset:3072
    v_mov_b32 v64, v80
    v_mov_b32 v65, v81
    v_mov_b32 v66, v82
    v_mov_b32 v67, v83
    v_mov_b32 v68, v84
    v_mov_b32 v69, v85
    v_mov_b32 v70, v86
    v_mov_b32 v71, v87
    v_mov_b32 v72, v88
    v_mov_b32 v73, v89
    v_mov_b32 v74, v90
    v_mov_b32 v75, v91
    v_mov_b32 v76, v92
    v_mov_b32 v77, v93
    v_mov_b32 v78, v94
    v_mov_b32 v79, v95
L_cx2:
    s_waitcnt lgkmcnt(0)
    s_barrier
    s_xor_b32 s27, s21, 1
    s_lshl_b32 s27, s27, 12
    s_add_u32 s27, s27, s25
    v_add_u32 v4, s27, v3
    ds_read_b128 v[80:83], v4 offset:0
    ds_read_b128 v[84:87], v4 offset:1024
    ds_read_b128 v[88:91], v4 offset:2048
    ds_read_b128 v[92:95], v4 offset:3072
    s_movk_i32 s40, 80
    v_mul_lo_u32 v5, v14, s40
    v_lshl_add_u32 v5, v15, 3, v5
    s_mul_i32 s27, s21, 2560
    s_add_u32 s27, s27, s25
    s_add_u32 s27, s27, 35840
    v_add_u32 v5, s27, v5
    ds_read_b64 v[96:97], v5 offset:0
    ds_read_b64 v[98:99], v5 offset:16
    ds_read_b64 v[100:101], v5 offset:32
    ds_read_b64 v[102:103], v5 offset:48
    v_lshlrev_b32 v6, 6, v14
    v_lshl_add_u32 v6, v15, 3, v6
    s_lshl_b32 s27, s22, 12
    s_lshl_b32 s28, s21, 11
    s_add_u32 s27, s27, s28
    v_add_u32 v9, s27, v3
    s_add_u32 s28, s28, s25
    s_add_u32 s28, s28, 8192
    v_add_u32 v7, s28, v6
    v_add_u32 v8, s28, v3
    v_add_u32 v6, s27, v6
    s_waitcnt lgkmcnt(0)
    v_lshlrev_b32 v24, 16, v96
    v_and_b32 v25, 0xffff0000, v96
    v_lshlrev_b32 v26, 16, v97
    v_and_b32 v27, 0xffff0000, v97
    v_add_f32 v64, v64, v80
    v_cvt_pk_bf16_f32 v64, v64, v64
    v_lshlrev_b32 v64, 16, v64
    v_mul_f32 v24, s24, v24
    v_cvt_pk_bf16_f32 v24, v24, v24
    v_lshlrev_b32 v24, 16, v24
    v_add_f32 v64, v64, v24
    v_add_f32 v65, v65, v81
    v_cvt_pk_bf16_f32 v65, v65, v65
    v_lshlrev_b32 v65, 16, v65
    v_mul_f32 v25, s24, v25
    v_cvt_pk_bf16_f32 v25, v25, v25
    v_lshlrev_b32 v25, 16, v25
    v_add_f32 v65, v65, v25
    v_add_f32 v66, v66, v82
    v_cvt_pk_bf16_f32 v66, v66, v66
    v_lshlrev_b32 v66, 16, v66
    v_mul_f32 v26, s24, v26
    v_cvt_pk_bf16_f32 v26, v26, v26
    v_lshlrev_b32 v26, 16, v26
    v_add_f32 v66, v66, v26
    v_add_f32 v67, v67, v83
    v_cvt_pk_bf16_f32 v67, v67, v67
    v_lshlrev_b32 v67, 16, v67
    v_mul_f32 v27, s24, v27
    v_cvt_pk_bf16_f32 v27, v27, v27
    v_lshlrev_b32 v27, 16, v27
    v_add_f32 v67, v67, v27
    v_cvt_pk_bf16_f32 v30, v64, v65
    v_cvt_pk_bf16_f32 v31, v66, v67
    ds_write_b64 v7, v[30:31] offset:0
    s_nop 1
    v_lshlrev_b32 v24, 16, v98
    v_and_b32 v25, 0xffff0000, v98
    v_lshlrev_b32 v26, 16, v99
    v_and_b32 v27, 0xffff0000, v99
    v_add_f32 v68, v68, v84
    v_cvt_pk_bf16_f32 v68, v68, v68
    v_lshlrev_b32 v68, 16, v68
    v_mul_f32 v24, s24, v24
    v_cvt_pk_bf16_f32 v24, v24, v24
    v_lshlrev_b32 v24, 16, v24
    v_add_f32 v68, v68, v24
    v_add_f32 v69, v69, v85
    v_cvt_pk_bf16_f32 v69, v69, v69
    v_lshlrev_b32 v69, 16, v69
    v_mul_f32 v25, s24, v25
    v_cvt_pk_bf16_f32 v25, v25, v25
    v_lshlrev_b32 v25, 16, v25
    v_add_f32 v69, v69, v25
    v_add_f32 v70, v70, v86
    v_cvt_pk_bf16_f32 v70, v70, v70
    v_lshlrev_b32 v70, 16, v70
    v_mul_f32 v26, s24, v26
    v_cvt_pk_bf16_f32 v26, v26, v26
    v_lshlrev_b32 v26, 16, v26
    v_add_f32 v70, v70, v26
    v_add_f32 v71, v71, v87
    v_cvt_pk_bf16_f32 v71, v71, v71
    v_lshlrev_b32 v71, 16, v71
    v_mul_f32 v27, s24, v27
    v_cvt_pk_bf16_f32 v27, v27, v27
    v_lshlrev_b32 v27, 16, v27
    v_add_f32 v71, v71, v27
    v_cvt_pk_bf16_f32 v30, v68, v69
    v_cvt_pk_bf16_f32 v31, v70, v71
    ds_write_b64 v7, v[30:31] offset:16
    s_nop 1
    v_lshlrev_b32 v24, 16, v100
    v_and_b32 v25, 0xffff0000, v100
    v_lshlrev_b32 v26, 16, v101
    v_and_b32 v27, 0xffff0000, v101
    v_add_f32 v72, v72, v88
    v_cvt_pk_bf16_f32 v72, v72, v72
    v_lshlrev_b32 v72, 16, v72
    v_mul_f32 v24, s24, v24
    v_cvt_pk_bf16_f32 v24, v24, v24
    v_lshlrev_b32 v24, 16, v24
    v_add_f32 v72, v72, v24
    v_add_f32 v73, v73, v89
    v_cvt_pk_bf16_f32 v73, v73, v73
    v_lshlrev_b32 v73, 16, v73
    v_mul_f32 v25, s24, v25
    v_cvt_pk_bf16_f32 v25, v25, v25
    v_lshlrev_b32 v25, 16, v25
    v_add_f32 v73, v73, v25
    v_add_f32 v74, v74, v90
    v_cvt_pk_bf16_f32 v74, v74, v74
    v_lshlrev_b32 v74, 16, v74
    v_mul_f32 v26, s24, v26
    v_cvt_pk_bf16_f32 v26, v26, v26
    v_lshlrev_b32 v26, 16, v26
    v_add_f32 v74, v74, v26
    v_add_f32 v75, v75, v91
    v_cvt_pk_bf16_f32 v75, v75, v75
    v_lshlrev_b32 v75, 16, v75
    v_mul_f32 v27, s24, v27
    v_cvt_pk_bf16_f32 v27, v27, v27
    v_lshlrev_b32 v27, 16, v27
    v_add_f32 v75, v75, v27
    v_cvt_pk_bf16_f32 v30, v72, v73
    v_cvt_pk_bf16_f32 v31, v74, v75
    ds_write_b64 v7, v[30:31] offset:32
    s_nop 1
    v_lshlrev_b32 v24, 16, v102
    v_and_b32 v25, 0xffff0000, v102
    v_lshlrev_b32 v26, 16, v103
    v_and_b32 v27, 0xffff0000, v103
    v_add_f32 v76, v76, v92
    v_cvt_pk_bf16_f32 v76, v76, v76
    v_lshlrev_b32 v76, 16, v76
    v_mul_f32 v24, s24, v24
    v_cvt_pk_bf16_f32 v24, v24, v24
    v_lshlrev_b32 v24, 16, v24
    v_add_f32 v76, v76, v24
    v_add_f32 v77, v77, v93
    v_cvt_pk_bf16_f32 v77, v77, v77
    v_lshlrev_b32 v77, 16, v77
    v_mul_f32 v25, s24, v25
    v_cvt_pk_bf16_f32 v25, v25, v25
    v_lshlrev_b32 v25, 16, v25
    v_add_f32 v77, v77, v25
    v_add_f32 v78, v78, v94
    v_cvt_pk_bf16_f32 v78, v78, v78
    v_lshlrev_b32 v78, 16, v78
    v_mul_f32 v26, s24, v26
    v_cvt_pk_bf16_f32 v26, v26, v26
    v_lshlrev_b32 v26, 16, v26
    v_add_f32 v78, v78, v26
    v_add_f32 v79, v79, v95
    v_cvt_pk_bf16_f32 v79, v79, v79
    v_lshlrev_b32 v79, 16, v79
    v_mul_f32 v27, s24, v27
    v_cvt_pk_bf16_f32 v27, v27, v27
    v_lshlrev_b32 v27, 16, v27
    v_add_f32 v79, v79, v27
    v_cvt_pk_bf16_f32 v30, v76, v77
    v_cvt_pk_bf16_f32 v31, v78, v79
    ds_write_b64 v7, v[30:31] offset:48
    s_nop 1
    s_waitcnt lgkmcnt(0)
    ds_read_b128 v[64:67], v8
    ds_read_b128 v[68:71], v8 offset:1024
    s_waitcnt lgkmcnt(1)
    buffer_store_dwordx4 v[64:67], v9, s[16:19], 0 offen sc0 sc1
    s_waitcnt lgkmcnt(0)
    buffer_store_dwordx4 v[68:71], v9, s[16:19], 0 offen offset:1024 sc0 sc1
    s_lshr_b32 s40, s2, 5
    s_lshl_b32 s40, s40, 10
    s_and_b32 s41, s2, 31
    s_lshl_b32 s41, s41, 3
    s_add_u32 s40, s40, s41
    s_add_u32 s76, s40, 167936
    s_mov_b32 s77, 8
    s_mov_b32 s78, 15
    s_mov_b32 s79, 63
L_cold:
    s_waitcnt vmcnt(0)
    s_barrier
    s_cmp_lg_u32 s3, 0
    s_cbranch_scc1 L_cend
    v_and_b32 v252, 63, v0
    v_lshlrev_b32 v252, s77, v252
L_tr_25:
    s_cmp_lg_u64 s[70:71], 0
    s_cbranch_scc1 L_tro_26
    v_mov_b32 v248, 0
    global_load_dwordx2 v[248:249], v248, s[68:69] sc0 sc1
    s_waitcnt vmcnt(0)
    v_readfirstlane_b32 s70, v248
    v_readfirstlane_b32 s71, v249
    s_branch L_tr_25
L_tro_26:
    s_memrealtime s[56:57]
    s_waitcnt lgkmcnt(0)
    v_mov_b32 v250, s56
    v_mov_b32 v251, s57
    s_mov_b32 exec_lo, s78
    s_mov_b32 exec_hi, 0
    buffer_store_dwordx2 v[250:251], v252, s[64:67], s76 offen sc0 sc1
    s_mov_b64 exec, -1
L_cend:
    s_endpgm
L_fin:
    s_barrier
    s_sub_u32 s47, s2, 256
    s_and_b32 s41, s47, 7
    s_lshr_b32 s40, s47, 3
    s_sub_u32 s42, s40, 28
    s_and_b32 s43, s42, 1
    s_add_u32 s43, s43, 14
    s_lshr_b32 s42, s42, 1
    s_cmp_ge_u32 s40, 14
    s_cselect_b32 s20, 1, 0
    s_cselect_b32 s21, 14, 0
    s_sub_u32 s21, s40, s21
    s_cmp_ge_u32 s40, 28
    s_cselect_b32 s20, s42, s20
    s_cselect_b32 s21, s43, s21
    s_lshl_b32 s20, s20, 3
    s_add_u32 s41, s41, s20
    s_and_b32 s20, s21, 7
    s_lshr_b32 s21, s21, 3
    s_lshl_b32 s40, s41, 1
    s_add_u32 s21, s21, s40
    s_mov_b32 s63, s41
    v_and_b32 v1, 31, v0
    v_min_u32 v3, 27, v1
    s_lshl_b32 s42, s21, 9
    s_add_u32 s42, s42, 180224
    v_lshl_add_u32 v2, v3, 3, s42
    v_and_b32 v4, 32, v0
    v_lshl_add_u32 v2, v4, 3, v2
    v_mov_b32 v254, v2
    v_lshrrev_b32 v2, 1, v3
    v_cmp_eq_u32 s[54:55], s79, v2
    s_lshl_b32 s42, s20, 10
    s_and_b32 s43, s21, 3
    s_lshl_b32 s43, s43, 8
    s_add_u32 s42, s42, s43
    s_add_u32 s42, s42, 167936
    v_lshl_add_u32 v253, v1, 3, s42
    v_lshrrev_b32 v1, 6, v0
    s_nop 0
    v_readfirstlane_b32 s3, v1
    s_cmp_lg_u32 s3, 1
    s_cbranch_scc1 L_ep_27
    s_cmp_lt_u32 s79, 62
    s_cbranch_scc1 L_ep_27
    s_mov_b32 exec_hi, 0
    buffer_load_dwordx2 v[240:241], v254, s[64:67], 0 offen sc0 sc1
    s_mov_b64 exec, -1
L_ep_27:
    s_waitcnt lgkmcnt(0)
    s_mov_b32 s8, s48
    s_mov_b32 s9, s49
    s_mov_b32 s10, 1835008
    s_mov_b32 s11, 0x00020000
    s_add_u32 s12, s4, 11010048
    s_addc_u32 s13, s5, 0
    s_mov_b32 s14, 7340032
    s_mov_b32 s15, 0x00020000
    s_add_u32 s16, s4, 18874368
    s_addc_u32 s17, s5, 0
    s_mov_b32 s18, 2097152
    s_mov_b32 s19, 0x00020000
    s_mov_b32 s24, s6
    s_mov_b32 s25, s7
    s_mov_b32 s26, 1024
    s_mov_b32 s27, 0x00020000
    s_mov_b32 s32, s50
    s_mov_b32 s33, s51
    s_mov_b32 s34, 2097152
    s_mov_b32 s35, 0x00020000
    s_mov_b32 s36, s52
    s_mov_b32 s37, s53
    s_mov_b32 s38, 2097152
    s_mov_b32 s39, 0x00020000
    s_mul_i32 s22, s20, 128
    s_mul_i32 s23, s21, 229376
    v_and_b32 v12, 63, v0
    v_lshrrev_b32 v13, 6, v0
    v_and_b32 v14, 31, v12
    v_lshrrev_b32 v15, 5, v12
    v_readfirstlane_b32 s3, v13
    v_lshrrev_b32 v1, 3, v12
    v_lshl_add_u32 v1, v13, 3, v1
    v_and_b32 v2, 7, v12
    v_lshrrev_b32 v3, 1, v1
    v_and_b32 v3, 7, v3
    v_xor_b32 v2, v2, v3
    v_lshlrev_b32 v2, 4, v2
    s_mov_b32 s40, 3584
    v_mul_lo_u32 v3, v1, s40
    v_add3_u32 v22, v3, v2, s23
    v_add_u32 v23, 114688, v22
    v_lshrrev_b32 v1, 3, v12
    v_lshl_add_u32 v1, v13, 3, v1
    v_and_b32 v2, 7, v12
    v_lshrrev_b32 v3, 4, v12
    v_and_b32 v3, 1, v3
    v_lshlrev_b32 v3, 2, v3
    v_xor_b32 v2, v2, v3
    v_lshlrev_b32 v2, 4, v2
    s_mov_b32 s40, 1024
    v_mul_lo_u32 v3, v1, s40
    v_add3_u32 v20, v3, v2, s22
    v_add_u32 v21, 32768, v20
    s_lshl_b32 s46, s3, 10
    s_movk_i32 s41, 0
    s_mov_b32 s45, 0
    s_add_u32 m0, s46, 0
    s_nop 0
    buffer_load_dwordx4 v20, s[8:11], s45 offen lds
    s_add_u32 m0, s46, 4096
    s_nop 0
    buffer_load_dwordx4 v21, s[8:11], s45 offen lds
    s_movk_i32 s41, 256
    s_mov_b32 s45, 131072
    s_add_u32 m0, s46, 16384
    s_nop 0
    buffer_load_dwordx4 v20, s[8:11], s45 offen lds
    s_add_u32 m0, s46, 20480
    s_nop 0
    buffer_load_dwordx4 v21, s[8:11], s45 offen lds
    s_movk_i32 s41, 512
    s_mov_b32 s45, 262144
    s_add_u32 m0, s46, 32768
    s_nop 0
    buffer_load_dwordx4 v20, s[8:11], s45 offen lds
    s_add_u32 m0, s46, 36864
    s_nop 0
    buffer_load_dwordx4 v21, s[8:11], s45 offen lds
    s_movk_i32 s41, 768
    s_mov_b32 s45, 393216
    s_add_u32 m0, s46, 49152
    s_nop 0
    buffer_load_dwordx4 v20, s[8:11], s45 offen lds
    s_add_u32 m0, s46, 53248
    s_nop 0
    buffer_load_dwordx4 v21, s[8:11], s45 offen lds
    v_lshrrev_b32 v3, 1, v14
    v_and_b32 v3, 7, v3
    v_lshl_add_u32 v4, v13, 1, v15
    v_add_u32 v5, 2, v4
    v_lshlrev_b32 v6, 7, v14
    v_add_u32 v7, 8192, v6
    v_xor_b32 v4, v4, v3
    v_xor_b32 v5, v5, v3
    v_lshl_add_u32 v28, v4, 4, v6
    v_lshl_add_u32 v29, v5, 4, v6
    v_lshl_add_u32 v30, v4, 4, v7
    v_lshl_add_u32 v31, v5, 4, v7
    v_and_b32 v3, 15, v12
    v_lshrrev_b32 v4, 2, v3
    v_lshl_add_u32 v4, v15, 3, v4
    v_lshl_add_u32 v4, v13, 4, v4
    v_lshlrev_b32 v4, 7, v4
    v_and_b32 v5, 1, v3
    v_lshl_add_u32 v4, v5, 3, v4
    v_and_b32 v5, 3, v3
    v_lshrrev_b32 v5, 1, v5
    v_lshrrev_b32 v6, 4, v12
    v_and_b32 v6, 1, v6
    v_lshl_add_u32 v5, v6, 1, v5
    v_lshrrev_b32 v6, 3, v3
    v_lshlrev_b32 v6, 2, v6
    v_xor_b32 v7, v5, v6
    v_lshl_add_u32 v28, v7, 4, v4
    v_add_u32 v5, 4, v5
    v_xor_b32 v7, v5, v6
    v_lshl_add_u32 v29, v7, 4, v4
    s_and_b32 s40, s3, 1
    s_lshl_b32 s40, s40, 12
    v_or_b32 v30, s40, v30
    v_xor_b32 v31, 0x1000, v30
    s_bitcmp1_b32 s3, 1
    s_cbranch_scc0 L_xq_29
    v_swap_b32 v28, v29
L_xq_29:
    v_add_u32 v32, 0x10000, v28
    v_add_u32 v33, 0x10000, v29
    v_add_u32 v34, 0x10000, v30
    v_add_u32 v35, 0x10000, v31
    s_cmp_ge_u32 s79, 62
    s_cbranch_scc1 L_cv_38
    s_cmp_lg_u32 s3, 1
    s_cbranch_scc1 L_q_39
    s_mov_b32 exec_hi, 0
    buffer_load_dwordx2 v[244:245], v254, s[64:67], 0 offen sc0 sc1
    s_mov_b64 exec, -1
    s_mov_b32 s61, 0
    s_waitcnt vmcnt(0)
    s_branch L_spin_31
L_q_39:
    s_branch L_w0_30
L_cv_38:
    s_cmp_lg_u32 s3, 1
    s_cbranch_scc1 L_np_35
    s_mov_b32 exec_hi, 0
    buffer_load_dwordx2 v[244:245], v254, s[64:67], 0 offen sc0 sc1
    s_mov_b64 exec, -1
    s_cmp_ge_u32 s79, 62
    s_cbranch_scc1 L_ns_37
    s_waitcnt vmcnt(10)
    s_branch L_np2_36
L_np_35:
    s_cmp_ge_u32 s79, 62
    s_cbranch_scc1 L_ns_37
    s_waitcnt vmcnt(8)
L_np2_36:
    s_barrier
    s_cmp_lg_u32 s3, 0
    s_cbranch_scc1 L_ns_37
    v_and_b32 v252, 63, v0
    v_lshlrev_b32 v252, s77, v252
L_tr_40:
    s_cmp_lg_u64 s[70:71], 0
    s_cbranch_scc1 L_tro_41
    v_mov_b32 v248, 0
    global_load_dwordx2 v[248:249], v248, s[68:69] sc0 sc1
    s_waitcnt vmcnt(0)
    v_readfirstlane_b32 s70, v248
    v_readfirstlane_b32 s71, v249
    s_branch L_tr_40
L_tro_41:
    s_memrealtime s[56:57]
    s_waitcnt lgkmcnt(0)
    v_mov_b32 v250, s56
    v_mov_b32 v251, s57
    s_mov_b32 exec_lo, s78
    s_mov_b32 exec_hi, 0
    buffer_store_dwordx2 v[250:251], v252, s[64:67], s76 offen sc0 sc1
    s_mov_b64 exec, -1
L_ns_37:
    s_cmp_lg_u32 s3, 1
    s_cbranch_scc1 L_w0_30
L_tr_42:
    s_cmp_lg_u64 s[70:71], 0
    s_cbranch_scc1 L_tro_43
    v_mov_b32 v248, 0
    global_load_dwordx2 v[248:249], v248, s[68:69] sc0 sc1
    s_waitcnt vmcnt(0)
    v_readfirstlane_b32 s70, v248
    v_readfirstlane_b32 s71, v249
    s_branch L_tr_42
L_tro_43:
    s_mov_b32 s61, 0
    s_waitcnt vmcnt(9)
    s_memrealtime s[56:57]
    s_waitcnt lgkmcnt(0)
    s_add_u32 s56, s56, 128
    s_addc_u32 s57, s57, 0
    v_cmp_ge_u64 vcc, v[240:241], s[70:71]
    v_cmp_lt_u64 s[56:57], v[240:241], s[56:57]
    s_and_b64 s[56:57], s[56:57], vcc
    s_or_b64 s[56:57], s[56:57], s[54:55]
    s_mov_b32 s57, -1
    s_cmp_eq_u64 s[56:57], -1
    s_cbranch_scc1 L_ok_32
    s_waitcnt vmcnt(0)
L_spin_31:
    s_memrealtime s[56:57]
    s_waitcnt lgkmcnt(0)
    s_add_u32 s56, s56, 128
    s_addc_u32 s57, s57, 0
    v_cmp_ge_u64 vcc, v[244:245], s[70:71]
    v_cmp_lt_u64 s[56:57], v[244:245], s[56:57]
    s_and_b64 s[56:57], s[56:57], vcc
    s_or_b64 s[56:57], s[56:57], s[54:55]
    s_mov_b32 s57, -1
    s_cmp_eq_u64 s[56:57], -1
    s_cbranch_scc1 L_ok_32
    s_add_u32 s61, s61, 1
    s_ff0_i32_b64 s62, s[56:57]
    s_cmp_ge_u32 s61, 4000
    s_cbranch_scc1 L_dec_33
    s_sleep 4
    s_mov_b32 exec_hi, 0
    buffer_load_dwordx2 v[244:245], v254, s[64:67], 0 offen sc0 sc1
    s_mov_b64 exec, -1
    s_waitcnt vmcnt(0)
    s_branch L_spin_31
L_ok_32:
    s_mov_b32 s62, -1
L_dec_33:
    v_mov_b32 v1, s62
    v_lshlrev_b32 v2, 10, v12
    v_add_u32 v2, 65536, v2
    s_mov_b64 exec, 15
    ds_write_b32 v2, v1
    s_mov_b64 exec, -1
    s_waitcnt lgkmcnt(0)
L_w0_30:
    s_barrier
    s_add_u32 s42, s46, 65536
    v_mov_b32 v2, s42
    ds_read_b32 v1, v2
    s_waitcnt lgkmcnt(0)
    v_readfirstlane_b32 s62, v1
    s_cmp_eq_u32 s62, -1
    s_cbranch_scc1 L_go_34
    s_lshr_b32 s20, s62, 1
    s_mov_b32 s21, s63
    s_load_dwordx2 s[44:45], s[0:1], 0
    s_waitcnt vmcnt(0)
    s_cmp_ge_u32 s79, 62
    s_cbranch_scc1 L_sb_44
    s_cmp_eq_u32 s3, 1
    s_cbranch_scc1 L_sb_44
    s_cmp_lg_u32 s3, 0
    s_cbranch_scc1 L_sb2_45
    s_mov_b64 exec, 1
    buffer_store_dwordx4 v[188:191], off, s[64:67], s76 offset:256 sc0 sc1
    s_mov_b64 exec, -1
    s_branch L_sb_44
L_sb2_45:
    s_mov_b64 exec, 1
    buffer_store_dwordx2 v[190:191], off, s[64:67], s76 offset:256 sc0 sc1
    s_mov_b64 exec, -1
L_sb_44:
    s_barrier
    s_cmp_lg_u32 s79, 63
    s_cbranch_scc1 L_g1_lo
    s_cmp_lg_u32 s3, 0
    s_cbranch_scc1 L_g1_lo
    v_and_b32 v252, 63, v0
    v_lshlrev_b32 v252, s77, v252
L_tr_46:
    s_cmp_lg_u64 s[70:71], 0
    s_cbranch_scc1 L_tro_47
    v_mov_b32 v248, 0
    global_load_dwordx2 v[248:249], v248, s[68:69] sc0 sc1
    s_waitcnt vmcnt(0)
    v_readfirstlane_b32 s70, v248
    v_readfirstlane_b32 s71, v249
    s_branch L_tr_46
L_tro_47:
    s_memrealtime s[56:57]
    s_waitcnt lgkmcnt(0)
    v_mov_b32 v250, s56
    v_mov_b32 v251, s57
    s_mov_b32 exec_lo, s78
    s_mov_b32 exec_hi, 0
    buffer_store_dwordx2 v[250:251], v252, s[64:67], s76 offen sc0 sc1
    s_mov_b64 exec, -1
    s_branch L_g1_lo
L_go_34:
    s_movk_i32 s41, 0
    s_mov_b32 s45, 0
    s_add_u32 m0, s46, 8192
    s_nop 0
    buffer_load_dwordx4 v22, s[12:15], s41 offen lds
    s_add_u32 m0, s46, 12288
    s_nop 0
    buffer_load_dwordx4 v23, s[12:15], s41 offen lds
    s_movk_i32 s41, 256
    s_mov_b32 s45, 131072
    s_add_u32 m0, s46, 24576
    s_nop 0
    buffer_load_dwordx4 v22, s[12:15], s41 offen lds
    s_add_u32 m0, s46, 28672
    s_nop 0
    buffer_load_dwordx4 v23, s[12:15], s41 offen lds
    s_movk_i32 s41, 512
    s_mov_b32 s45, 262144
    s_add_u32 m0, s46, 40960
    s_nop 0
    buffer_load_dwordx4 v22, s[12:15], s41 offen lds
    s_add_u32 m0, s46, 45056
    s_nop 0
    buffer_load_dwordx4 v23, s[12:15], s41 offen lds
    s_movk_i32 s41, 768
    s_mov_b32 s45, 393216
    s_add_u32 m0, s46, 57344
    s_nop 0
    buffer_load_dwordx4 v22, s[12:15], s41 offen lds
    s_add_u32 m0, s46, 61440
    s_nop 0
    buffer_load_dwordx4 v23, s[12:15], s41 offen lds
    s_movk_i32 s41, 1024
    s_mov_b32 s45, 524288
    s_add_u32 m0, s46, 65536
    s_nop 0
    buffer_load_dwordx4 v20, s[8:11], s45 offen lds
    s_add_u32 m0, s46, 69632
    s_nop 0
    buffer_load_dwordx4 v21, s[8:11], s45 offen lds
    s_add_u32 m0, s46, 73728
    s_nop 0
    buffer_load_dwordx4 v22, s[12:15], s41 offen lds
    s_add_u32 m0, s46, 77824
    s_nop 0
    buffer_load_dwordx4 v23, s[12:15], s41 offen lds
    s_waitcnt vmcnt(10)
    s_barrier
    ds_read_b64_tr_b16 v[128:129], v28 offset:0
    ds_read_b64_tr_b16 v[130:131], v28 offset:512
    ds_read_b64_tr_b16 v[132:133], v29 offset:0
    ds_read_b64_tr_b16 v[134:135], v29 offset:512
    ds_read_b128 v[136:139], v30 offset:0
    ds_read_b128 v[140:143], v31 offset:0
    s_waitcnt lgkmcnt(0)
    v_mfma_f32_32x32x16_bf16 v[64:79], v[128:131], v[136:139], 0
    s_waitcnt vmcnt(8)
    s_barrier
    s_cmp_ge_u32 s79, 62
    s_cbranch_scc1 L_sb_48
    s_cmp_eq_u32 s3, 1
    s_cbranch_scc1 L_sb_48
    s_cmp_lg_u32 s3, 0
    s_cbranch_scc1 L_sb2_49
    s_mov_b64 exec, 1
    buffer_store_dwordx4 v[188:191], off, s[64:67], s76 offset:256 sc0 sc1
    s_mov_b64 exec, -1
    s_branch L_sb_48
L_sb2_49:
    s_mov_b64 exec, 1
    buffer_store_dwordx2 v[190:191], off, s[64:67], s76 offset:256 sc0 sc1
    s_mov_b64 exec, -1
L_sb_48:
    ds_read_b64_tr_b16 v[160:161], v28 offset:16384
    ds_read_b64_tr_b16 v[162:163], v28 offset:16896
    ds_read_b64_tr_b16 v[164:165], v29 offset:16384
    s_movk_i32 s41, 1280
    s_mov_b32 s45, 655360
    s_add_u32 m0, s46, 0
    s_nop 0
    buffer_load_dwordx4 v20, s[8:11], s45 offen lds
    v_mfma_f32_32x32x16_bf16 v[80:95], v[128:131], v[140:143], 0
    ds_read_b64_tr_b16 v[166:167], v29 offset:16896
    ds_read_b128 v[168:171], v30 offset:16384
    ds_read_b128 v[172:175], v31 offset:16384
    s_add_u32 m0, s46, 4096
    s_nop 0
    buffer_load_dwordx4 v21, s[8:11], s45 offen lds
    v_mfma_f32_32x32x16_bf16 v[96:111], v[132:135], v[136:139], 0
    s_add_u32 m0, s46, 8192
    s_nop 0
    buffer_load_dwordx4 v22, s[12:15], s41 offen lds
    v_mfma_f32_32x32x16_bf16 v[112:127], v[132:135], v[140:143], 0
    s_add_u32 m0, s46, 12288
    s_nop 0
    buffer_load_dwordx4 v23, s[12:15], s41 offen lds
    s_waitcnt lgkmcnt(0)
    v_mfma_f32_32x32x16_bf16 v[64:79], v[160:163], v[168:171], v[64:79]
    s_waitcnt vmcnt(10)
    s_barrier
    s_cmp_lg_u32 s79, 63
    s_cbranch_scc1 L_cs_50
    s_cmp_lg_u32 s3, 0
    s_cbranch_scc1 L_cs_50
    v_and_b32 v252, 63, v0
    v_lshlrev_b32 v252, s77, v252
L_tr_51:
    s_cmp_lg_u64 s[70:71], 0
    s_cbranch_scc1 L_tro_52
    v_mov_b32 v248, 0
    global_load_dwordx2 v[248:249], v248, s[68:69] sc0 sc1
    s_waitcnt vmcnt(0)
    v_readfirstlane_b32 s70, v248
    v_readfirstlane_b32 s71, v249
    s_branch L_tr_51
L_tro_52:
    s_memrealtime s[56:57]
    s_waitcnt lgkmcnt(0)
    v_mov_b32 v250, s56
    v_mov_b32 v251, s57
    s_mov_b32 exec_lo, s78
    s_mov_b32 exec_hi, 0
    buffer_store_dwordx2 v[250:251], v252, s[64:67], s76 offen sc0 sc1
    s_mov_b64 exec, -1
L_cs_50:
    ds_read_b64_tr_b16 v[128:129], v28 offset:32768
    ds_read_b64_tr_b16 v[130:131], v28 offset:33280
    ds_read_b64_tr_b16 v[132:133], v29 offset:32768
    s_movk_i32 s41, 1536
    s_mov_b32 s45, 786432
    s_add_u32 m0, s46, 16384
    s_nop 0
    buffer_load_dwordx4 v20, s[8:11], s45 offen lds
    v_mfma_f32_32x32x16_bf16 v[80:95], v[160:163], v[172:175], v[80:95]
    ds_read_b64_tr_b16 v[134:135], v29 offset:33280
    ds_read_b128 v[136:139], v30 offset:32768
    ds_read_b128 v[140:143], v31 offset:32768
    s_add_u32 m0, s46, 20480
    s_nop 0
    buffer_load_dwordx4 v21, s[8:11], s45 offen lds
    v_mfma_f32_32x32x16_bf16 v[96:111], v[164:167], v[168:171], v[96:111]
    s_add_u32 m0, s46, 24576
    s_nop 0
    buffer_load_dwordx4 v22, s[12:15], s41 offen lds
    v_mfma_f32_32x32x16_bf16 v[112:127], v[164:167], v[172:175], v[112:127]
    s_add_u32 m0, s46, 28672
    s_nop 0
    buffer_load_dwordx4 v23, s[12:15], s41 offen lds
    s_waitcnt lgkmcnt(0)
    v_mfma_f32_32x32x16_bf16 v[64:79], v[128:131], v[136:139], v[64:79]
    s_waitcnt vmcnt(12)
    s_barrier
    ds_read_b64_tr_b16 v[160:161], v28 offset:49152
    ds_read_b64_tr_b16 v[162:163], v28 offset:49664
    ds_read_b64_tr_b16 v[164:165], v29 offset:49152
    s_movk_i32 s41, 1792
    s_mov_b32 s45, 917504
    s_add_u32 m0, s46, 32768
    s_nop 0
    buffer_load_dwordx4 v20, s[8:11], s45 offen lds
    v_mfma_f32_32x32x16_bf16 v[80:95], v[128:131], v[140:143], v[80:95]
    ds_read_b64_tr_b16 v[166:167], v29 offset:49664
    ds_read_b128 v[168:171], v30 offset:49152
    ds_read_b128 v[172:175], v31 offset:49152
    s_add_u32 m0, s46, 36864
    s_nop 0
    buffer_load_dwordx4 v21, s[8:11], s45 offen lds
    v_mfma_f32_32x32x16_bf16 v[96:111], v[132:135], v[136:139], v[96:111]
    s_add_u32 m0, s46, 40960
    s_nop 0
    buffer_load_dwordx4 v22, s[12:15], s41 offen lds
    v_mfma_f32_32x32x16_bf16 v[112:127], v[132:135], v[140:143], v[112:127]
    s_add_u32 m0, s46, 45056
    s_nop 0
    buffer_load_dwordx4 v23, s[12:15], s41 offen lds
    s_waitcnt lgkmcnt(0)
    v_mfma_f32_32x32x16_bf16 v[64:79], v[160:163], v[168:171], v[64:79]
    s_waitcnt vmcnt(12)
    s_barrier
    ds_read_b64_tr_b16 v[128:129], v32 offset:0
    ds_read_b64_tr_b16 v[130:131], v32 offset:512
    ds_read_b64_tr_b16 v[132:133], v33 offset:0
    s_movk_i32 s41, 2048
    s_mov_b32 s45, 1048576
    s_add_u32 m0, s46, 49152
    s_nop 0
    buffer_load_dwordx4 v20, s[8:11], s45 offen lds
    v_mfma_f32_32x32x16_bf16 v[80:95], v[160:163], v[172:175], v[80:95]
    ds_read_b64_tr_b16 v[134:135], v33 offset:512
    ds_read_b128 v[136:139], v34 offset:0
    ds_read_b128 v[140:143], v35 offset:0
    s_add_u32 m0, s46, 53248
    s_nop 0
    buffer_load_dwordx4 v21, s[8:11], s45 offen lds
    v_mfma_f32_32x32x16_bf16 v[96:111], v[164:167], v[168:171], v[96:111]
    s_add_u32 m0, s46, 57344
    s_nop 0
    buffer_load_dwordx4 v22, s[12:15], s41 offen lds
    v_mfma_f32_32x32x16_bf16 v[112:127], v[164:167], v[172:175], v[112:127]
    s_add_u32 m0, s46, 61440
    s_nop 0
    buffer_load_dwordx4 v23, s[12:15], s41 offen lds
    s_waitcnt lgkmcnt(0)
    v_mfma_f32_32x32x16_bf16 v[64:79], v[128:131], v[136:139], v[64:79]
    s_waitcnt vmcnt(12)
    s_barrier
    ds_read_b64_tr_b16 v[160:161], v28 offset:0
    ds_read_b64_tr_b16 v[162:163], v28 offset:512
    ds_read_b64_tr_b16 v[164:165], v29 offset:0
    s_movk_i32 s41, 2304
    s_mov_b32 s45, 1179648
    s_add_u32 m0, s46, 65536
    s_nop 0
    buffer_load_dwordx4 v20, s[8:11], s45 offen lds
    v_mfma_f32_32x32x16_bf16 v[80:95], v[128:131], v[140:143], v[80:95]
    ds_read_b64_tr_b16 v[166:167], v29 offset:512
    ds_read_b128 v[168:171], v30 offset:0
    ds_read_b128 v[172:175], v31 offset:0
    s_add_u32 m0, s46, 69632
    s_nop 0
    buffer_load_dwordx4 v21, s[8:11], s45 offen lds
    v_mfma_f32_32x32x16_bf16 v[96:111], v[132:135], v[136:139], v[96:111]
    s_add_u32 m0, s46, 73728
    s_nop 0
    buffer_load_dwordx4 v22, s[12:15], s41 offen lds
    v_mfma_f32_32x32x16_bf16 v[112:127], v[132:135], v[140:143], v[112:127]
    s_add_u32 m0, s46, 77824
    s_nop 0
    buffer_load_dwordx4 v23, s[12:15], s41 offen lds
    s_waitcnt lgkmcnt(0)
    v_mfma_f32_32x32x16_bf16 v[64:79], v[160:163], v[168:171], v[64:79]
    s_waitcnt vmcnt(12)
    s_barrier
    s_cmp_lg_u32 s3, 1
    s_cbranch_scc1 L_pb_53
    s_mov_b32 exec_lo, 0
    buffer_load_dwordx2 v[244:245], v254, s[64:67], 0 offen sc0 sc1
    s_mov_b64 exec, -1
L_pb_53:
    ds_read_b64_tr_b16 v[128:129], v28 offset:16384
    ds_read_b64_tr_b16 v[130:131], v28 offset:16896
    ds_read_b64_tr_b16 v[132:133], v29 offset:16384
    s_movk_i32 s41, 2560
    s_mov_b32 s45, 1310720
    s_add_u32 m0, s46, 0
    s_nop 0
    buffer_load_dwordx4 v20, s[8:11], s45 offen lds
    v_mfma_f32_32x32x16_bf16 v[80:95], v[160:163], v[172:175], v[80:95]
    ds_read_b64_tr_b16 v[134:135], v29 offset:16896
    ds_read_b128 v[136:139], v30 offset:16384
    ds_read_b128 v[140:143], v31 offset:16384
    s_add_u32 m0, s46, 4096
    s_nop 0
    buffer_load_dwordx4 v21, s[8:11], s45 offen lds
    v_mfma_f32_32x32x16_bf16 v[96:111], v[164:167], v[168:171], v[96:111]
    s_add_u32 m0, s46, 8192
    s_nop 0
    buffer_load_dwordx4 v22, s[12:15], s41 offen lds
    v_mfma_f32_32x32x16_bf16 v[112:127], v[164:167], v[172:175], v[112:127]
    s_add_u32 m0, s46, 12288
    s_nop 0
    buffer_load_dwordx4 v23, s[12:15], s41 offen lds
    s_waitcnt lgkmcnt(0)
    v_mfma_f32_32x32x16_bf16 v[64:79], v[128:131], v[136:139], v[64:79]
    s_waitcnt vmcnt(12)
    s_barrier
    ds_read_b64_tr_b16 v[160:161], v28 offset:32768
    ds_read_b64_tr_b16 v[162:163], v28 offset:33280
    ds_read_b64_tr_b16 v[164:165], v29 offset:32768
    s_movk_i32 s41, 2816
    s_mov_b32 s45, 1441792
    s_add_u32 m0, s46, 16384
    s_nop 0
    buffer_load_dwordx4 v20, s[8:11], s45 offen lds
    v_mfma_f32_32x32x16_bf16 v[80:95], v[128:131], v[140:143], v[80:95]
    ds_read_b64_tr_b16 v[166:167], v29 offset:33280
    ds_read_b128 v[168:171], v30 offset:32768
    ds_read_b128 v[172:175], v31 offset:32768
    s_add_u32 m0, s46, 20480
    s_nop 0
    buffer_load_dwordx4 v21, s[8:11], s45 offen lds
    v_mfma_f32_32x32x16_bf16 v[96:111], v[132:135], v[136:139], v[96:111]
    s_add_u32 m0, s46, 24576
    s_nop 0
    buffer_load_dwordx4 v22, s[12:15], s41 offen lds
    v_mfma_f32_32x32x16_bf16 v[112:127], v[132:135], v[140:143], v[112:127]
    s_add_u32 m0, s46, 28672
    s_nop 0
    buffer_load_dwordx4 v23, s[12:15], s41 offen lds
    s_waitcnt lgkmcnt(0)
    v_mfma_f32_32x32x16_bf16 v[64:79], v[160:163], v[168:171], v[64:79]
    s_waitcnt vmcnt(12)
    s_barrier
    ds_read_b64_tr_b16 v[128:129], v28 offset:49152
    ds_read_b64_tr_b16 v[130:131], v28 offset:49664
    ds_read_b64_tr_b16 v[132:133], v29 offset:49152
    s_movk_i32 s41, 3072
    s_mov_b32 s45, 1572864
    s_add_u32 m0, s46, 32768
    s_nop 0
    buffer_load_dwordx4 v20, s[8:11], s45 offen lds
    v_mfma_f32_32x32x16_bf16 v[80:95], v[160:163], v[172:175], v[80:95]
    ds_read_b64_tr_b16 v[134:135], v29 offset:49664
    ds_read_b128 v[136:139], v30 offset:49152
    ds_read_b128 v[140:143], v31 offset:49152
    s_add_u32 m0, s46, 36864
    s_nop 0
    buffer_load_dwordx4 v21, s[8:11], s45 offen lds
    v_mfma_f32_32x32x16_bf16 v[96:111], v[164:167], v[168:171], v[96:111]
    s_add_u32 m0, s46, 40960
    s_nop 0
    buffer_load_dwordx4 v22, s[12:15], s41 offen lds
    v_mfma_f32_32x32x16_bf16 v[112:127], v[164:167], v[172:175], v[112:127]
    s_add_u32 m0, s46, 45056
    s_nop 0
    buffer_load_dwordx4 v23, s[12:15], s41 offen lds
    s_waitcnt lgkmcnt(0)
    v_mfma_f32_32x32x16_bf16 v[64:79], v[128:131], v[136:139], v[64:79]
    s_waitcnt vmcnt(12)
    s_barrier
    ds_read_b64_tr_b16 v[160:161], v32 offset:0
    ds_read_b64_tr_b16 v[162:163], v32 offset:512
    ds_read_b64_tr_b16 v[164:165], v33 offset:0
    s_movk_i32 s41, 3328
    s_mov_b32 s45, 1703936
    s_add_u32 m0, s46, 49152
    s_nop 0
    buffer_load_dwordx4 v20, s[8:11], s45 offen lds
    v_mfma_f32_32x32x16_bf16 v[80:95], v[128:131], v[140:143], v[80:95]
    ds_read_b64_tr_b16 v[166:167], v33 offset:512
    ds_read_b128 v[168:171], v34 offset:0
    ds_read_b128 v[172:175], v35 offset:0
    s_add_u32 m0, s46, 53248
    s_nop 0
    buffer_load_dwordx4 v21, s[8:11], s45 offen lds
    v_mfma_f32_32x32x16_bf16 v[96:111], v[132:135], v[136:139], v[96:111]
    s_add_u32 m0, s46, 57344
    s_nop 0
    buffer_load_dwordx4 v22, s[12:15], s41 offen lds
    v_mfma_f32_32x32x16_bf16 v[112:127], v[132:135], v[140:143], v[112:127]
    s_add_u32 m0, s46, 61440
    s_nop 0
    buffer_load_dwordx4 v23, s[12:15], s41 offen lds
    s_waitcnt lgkmcnt(0)
    v_mfma_f32_32x32x16_bf16 v[64:79], v[160:163], v[168:171], v[64:79]
    s_waitcnt vmcnt(12)
    s_cmp_lg_u32 s3, 1
    s_cbranch_scc1 L_pb_54
L_pbs_55:
    s_memrealtime s[56:57]
    s_waitcnt lgkmcnt(0)
    s_add_u32 s56, s56, 128
    s_addc_u32 s57, s57, 0
    v_cmp_ge_u64 vcc, v[244:245], s[70:71]
    v_cmp_lt_u64 s[56:57], v[244:245], s[56:57]
    s_and_b64 s[56:57], s[56:57], vcc
    s_or_b64 s[56:57], s[56:57], s[54:55]
    s_mov_b32 s56, -1
    s_cmp_eq_u64 s[56:57], -1
    s_cbranch_scc1 L_pb_54
    s_sleep 4
    s_mov_b32 exec_lo, 0
    buffer_load_dwordx2 v[244:245], v254, s[64:67], 0 offen sc0 sc1
    s_mov_b64 exec, -1
    s_waitcnt vmcnt(0)
    s_branch L_pbs_55
L_pb_54:
    s_barrier
    ds_read_b64_tr_b16 v[128:129], v28 offset:0
    ds_read_b64_tr_b16 v[130:131], v28 offset:512
    ds_read_b64_tr_b16 v[132:133], v29 offset:0
    s_movk_i32 s41, 128
    s_mov_b32 s45, 65536
    s_add_u32 m0, s46, 65536
    s_nop 0
    buffer_load_dwordx4 v20, s[8:11], s45 offen lds
    v_mfma_f32_32x32x16_bf16 v[80:95], v[160:163], v[172:175], v[80:95]
    ds_read_b64_tr_b16 v[134:135], v29 offset:512
    ds_read_b128 v[136:139], v30 offset:0
    ds_read_b128 v[140:143], v31 offset:0
    s_add_u32 m0, s46, 69632
    s_nop 0
    buffer_load_dwordx4 v21, s[8:11], s45 offen lds
    v_mfma_f32_32x32x16_bf16 v[96:111], v[164:167], v[168:171], v[96:111]
    s_add_u32 m0, s46, 73728
    s_nop 0
    buffer_load_dwordx4 v22, s[12:15], s41 offen lds
    v_mfma_f32_32x32x16_bf16 v[112:127], v[164:167], v[172:175], v[112:127]
    s_add_u32 m0, s46, 77824
    s_nop 0
    buffer_load_dwordx4 v23, s[12:15], s41 offen lds
    s_waitcnt lgkmcnt(0)
    v_mfma_f32_32x32x16_bf16 v[64:79], v[128:131], v[136:139], v[64:79]
    s_waitcnt vmcnt(12)
    s_barrier
    ds_read_b64_tr_b16 v[160:161], v28 offset:16384
    ds_read_b64_tr_b16 v[162:163], v28 offset:16896
    ds_read_b64_tr_b16 v[164:165], v29 offset:16384
    s_movk_i32 s41, 384
    s_mov_b32 s45, 196608
    s_add_u32 m0, s46, 0
    s_nop 0
    buffer_load_dwordx4 v20, s[8:11], s45 offen lds
    v_mfma_f32_32x32x16_bf16 v[80:95], v[128:131], v[140:143], v[80:95]
    ds_read_b64_tr_b16 v[166:167], v29 offset:16896
    ds_read_b128 v[168:171], v30 offset:16384
    ds_read_b128 v[172:175], v31 offset:16384
    s_add_u32 m0, s46, 4096
    s_nop 0
    buffer_load_dwordx4 v21, s[8:11], s45 offen lds
    v_mfma_f32_32x32x16_bf16 v[96:111], v[132:135], v[136:139], v[96:111]
    s_add_u32 m0, s46, 8192
    s_nop 0
    buffer_load_dwordx4 v22, s[12:15], s41 offen lds
    v_mfma_f32_32x32x16_bf16 v[112:127], v[132:135], v[140:143], v[112:127]
    s_add_u32 m0, s46, 12288
    s_nop 0
    buffer_load_dwordx4 v23, s[12:15], s41 offen lds
    s_waitcnt lgkmcnt(0)
    v_mfma_f32_32x32x16_bf16 v[64:79], v[160:163], v[168:171], v[64:79]
    s_waitcnt vmcnt(12)
    s_barrier
    ds_read_b64_tr_b16 v[128:129], v28 offset:32768
    ds_read_b64_tr_b16 v[130:131], v28 offset:33280
    ds_read_b64_tr_b16 v[132:133], v29 offset:32768
    s_movk_i32 s41, 640
    s_mov_b32 s45, 327680
    s_add_u32 m0, s46, 16384
    s_nop 0
    buffer_load_dwordx4 v20, s[8:11], s45 offen lds
    v_mfma_f32_32x32x16_bf16 v[80:95], v[160:163], v[172:175], v[80:95]
    ds_read_b64_tr_b16 v[134:135], v29 offset:33280
    ds_read_b128 v[136:139], v30 offset:32768
    ds_read_b128 v[140:143], v31 offset:32768
    s_add_u32 m0, s46, 20480
    s_nop 0
    buffer_load_dwordx4 v21, s[8:11], s45 offen lds
    v_mfma_f32_32x32x16_bf16 v[96:111], v[164:167], v[168:171], v[96:111]
    s_add_u32 m0, s46, 24576
    s_nop 0
    buffer_load_dwordx4 v22, s[12:15], s41 offen lds
    v_mfma_f32_32x32x16_bf16 v[112:127], v[164:167], v[172:175], v[112:127]
    s_add_u32 m0, s46, 28672
    s_nop 0
    buffer_load_dwordx4 v23, s[12:15], s41 offen lds
    s_waitcnt lgkmcnt(0)
    v_mfma_f32_32x32x16_bf16 v[64:79], v[128:131], v[136:139], v[64:79]
    s_waitcnt vmcnt(12)
    s_barrier
    ds_read_b64_tr_b16 v[160:161], v28 offset:49152
    ds_read_b64_tr_b16 v[162:163], v28 offset:49664
    ds_read_b64_tr_b16 v[164:165], v29 offset:49152
    s_movk_i32 s41, 896
    s_mov_b32 s45, 458752
    s_add_u32 m0, s46, 32768
    s_nop 0
    buffer_load_dwordx4 v20, s[8:11], s45 offen lds
    v_mfma_f32_32x32x16_bf16 v[80:95], v[128:131], v[140:143], v[80:95]
    ds_read_b64_tr_b16 v[166:167], v29 offset:49664
    ds_read_b128 v[168:171], v30 offset:49152
    ds_read_b128 v[172:175], v31 offset:49152
    s_add_u32 m0, s46, 36864
    s_nop 0
    buffer_load_dwordx4 v21, s[8:11], s45 offen lds
    v_mfma_f32_32x32x16_bf16 v[96:111], v[132:135], v[136:139], v[96:111]
    s_add_u32 m0, s46, 40960
    s_nop 0
    buffer_load_dwordx4 v22, s[12:15], s41 offen lds
    v_mfma_f32_32x32x16_bf16 v[112:127], v[132:135], v[140:143], v[112:127]
    s_add_u32 m0, s46, 45056
    s_nop 0
    buffer_load_dwordx4 v23, s[12:15], s41 offen lds
    s_waitcnt lgkmcnt(0)
    v_mfma_f32_32x32x16_bf16 v[64:79], v[160:163], v[168:171], v[64:79]
    s_waitcnt vmcnt(12)
    s_barrier
    ds_read_b64_tr_b16 v[128:129], v32 offset:0
    ds_read_b64_tr_b16 v[130:131], v32 offset:512
    ds_read_b64_tr_b16 v[132:133], v33 offset:0
    s_movk_i32 s41, 1152
    s_mov_b32 s45, 589824
    s_add_u32 m0, s46, 49152
    s_nop 0
    buffer_load_dwordx4 v20, s[8:11], s45 offen lds
    v_mfma_f32_32x32x16_bf16 v[80:95], v[160:163], v[172:175], v[80:95]
    ds_read_b64_tr_b16 v[134:135], v33 offset:512
    ds_read_b128 v[136:139], v34 offset:0
    ds_read_b128 v[140:143], v35 offset:0
    s_add_u32 m0, s46, 53248
    s_nop 0
    buffer_load_dwordx4 v21, s[8:11], s45 offen lds
    v_mfma_f32_32x32x16_bf16 v[96:111], v[164:167], v[168:171], v[96:111]
    s_add_u32 m0, s46, 57344
    s_nop 0
    buffer_load_dwordx4 v22, s[12:15], s41 offen lds
    v_mfma_f32_32x32x16_bf16 v[112:127], v[164:167], v[172:175], v[112:127]
    s_add_u32 m0, s46, 61440
    s_nop 0
    buffer_load_dwordx4 v23, s[12:15], s41 offen lds
    s_waitcnt lgkmcnt(0)
    v_mfma_f32_32x32x16_bf16 v[64:79], v[128:131], v[136:139], v[64:79]
    s_waitcnt vmcnt(12)
    s_barrier
    ds_read_b64_tr_b16 v[160:161], v28 offset:0
    ds_read_b64_tr_b16 v[162:163], v28 offset:512
    ds_read_b64_tr_b16 v[164:165], v29 offset:0
    s_movk_i32 s41, 1408
    s_mov_b32 s45, 720896
    s_add_u32 m0, s46, 65536
    s_nop 0
    buffer_load_dwordx4 v20, s[8:11], s45 offen lds
    v_mfma_f32_32x32x16_bf16 v[80:95], v[128:131], v[140:143], v[80:95]
    ds_read_b64_tr_b16 v[166:167], v29 offset:512
    ds_read_b128 v[168:171], v30 offset:0
    ds_read_b128 v[172:175], v31 offset:0
    s_add_u32 m0, s46, 69632
    s_nop 0
    buffer_load_dwordx4 v21, s[8:11], s45 offen lds
    v_mfma_f32_32x32x16_bf16 v[96:111], v[132:135], v[136:139], v[96:111]
    s_add_u32 m0, s46, 73728
    s_nop 0
    buffer_load_dwordx4 v22, s[12:15], s41 offen lds
    v_mfma_f32_32x32x16_bf16 v[112:127], v[132:135], v[140:143], v[112:127]
    s_add_u32 m0, s46, 77824
    s_nop 0
    buffer_load_dwordx4 v23, s[12:15], s41 offen lds
    s_waitcnt lgkmcnt(0)
    v_mfma_f32_32x32x16_bf16 v[64:79], v[160:163], v[168:171], v[64:79]
    s_waitcnt vmcnt(12)
    s_barrier
    ds_read_b64_tr_b16 v[128:129], v28 offset:16384
    ds_read_b64_tr_b16 v[130:131], v28 offset:16896
    ds_read_b64_tr_b16 v[132:133], v29 offset:16384
    s_movk_i32 s41, 1664
    s_mov_b32 s45, 851968
    s_add_u32 m0, s46, 0
    s_nop 0
    buffer_load_dwordx4 v20, s[8:11], s45 offen lds
    v_mfma_f32_32x32x16_bf16 v[80:95], v[160:163], v[172:175], v[80:95]
    ds_read_b64_tr_b16 v[134:135], v29 offset:16896
    ds_read_b128 v[136:139], v30 offset:16384
    ds_read_b128 v[140:143], v31 offset:16384
    s_add_u32 m0, s46, 4096
    s_nop 0
    buffer_load_dwordx4 v21, s[8:11], s45 offen lds
    v_mfma_f32_32x32x16_bf16 v[96:111], v[164:167], v[168:171], v[96:111]
    s_add_u32 m0, s46, 8192
    s_nop 0
    buffer_load_dwordx4 v22, s[12:15], s41 offen lds
    v_mfma_f32_32x32x16_bf16 v[112:127], v[164:167], v[172:175], v[112:127]
    s_add_u32 m0, s46, 12288
    s_nop 0
    buffer_load_dwordx4 v23, s[12:15], s41 offen lds
    s_waitcnt lgkmcnt(0)
    v_mfma_f32_32x32x16_bf16 v[64:79], v[128:131], v[136:139], v[64:79]
    s_waitcnt vmcnt(12)
    s_barrier
    ds_read_b64_tr_b16 v[160:161], v28 offset:32768
    ds_read_b64_tr_b16 v[162:163], v28 offset:33280
    ds_read_b64_tr_b16 v[164:165], v29 offset:32768
    s_movk_i32 s41, 1920
    s_mov_b32 s45, 983040
    s_add_u32 m0, s46, 16384
    s_nop 0
    buffer_load_dwordx4 v20, s[8:11], s45 offen lds
    v_mfma_f32_32x32x16_bf16 v[80:95], v[128:131], v[140:143], v[80:95]
    ds_read_b64_tr_b16 v[166:167], v29 offset:33280
    ds_read_b128 v[168:171], v30 offset:32768
    ds_read_b128 v[172:175], v31 offset:32768
    s_add_u32 m0, s46, 20480
    s_nop 0
    buffer_load_dwordx4 v21, s[8:11], s45 offen lds
    v_mfma_f32_32x32x16_bf16 v[96:111], v[132:135], v[136:139], v[96:111]
    s_add_u32 m0, s46, 24576
    s_nop 0
    buffer_load_dwordx4 v22, s[12:15], s41 offen lds
    v_mfma_f32_32x32x16_bf16 v[112:127], v[132:135], v[140:143], v[112:127]
    s_add_u32 m0, s46, 28672
    s_nop 0
    buffer_load_dwordx4 v23, s[12:15], s41 offen lds
    s_waitcnt lgkmcnt(0)
    v_mfma_f32_32x32x16_bf16 v[64:79], v[160:163], v[168:171], v[64:79]
    s_waitcnt vmcnt(12)
    s_barrier
    s_cmp_lg_u32 s3, 0
    s_cbranch_scc1 L_cw_56
    buffer_load_dwordx2 v[250:251], v253, s[64:67], 0 offen sc0 sc1
L_cw_56:
    ds_read_b64_tr_b16 v[128:129], v28 offset:49152
    ds_read_b64_tr_b16 v[130:131], v28 offset:49664
    ds_read_b64_tr_b16 v[132:133], v29 offset:49152
    s_movk_i32 s41, 2176
    s_mov_b32 s45, 1114112
    s_add_u32 m0, s46, 32768
    s_nop 0
    buffer_load_dwordx4 v20, s[8:11], s45 offen lds
    v_mfma_f32_32x32x16_bf16 v[80:95], v[160:163], v[172:175], v[80:95]
    ds_read_b64_tr_b16 v[134:135], v29 offset:49664
    ds_read_b128 v[136:139], v30 offset:49152
    ds_read_b128 v[140:143], v31 offset:49152
    s_add_u32 m0, s46, 36864
    s_nop 0
    buffer_load_dwordx4 v21, s[8:11], s45 offen lds
    v_mfma_f32_32x32x16_bf16 v[96:111], v[164:167], v[168:171], v[96:111]
    s_add_u32 m0, s46, 40960
    s_nop 0
    buffer_load_dwordx4 v22, s[12:15], s41 offen lds
    v_mfma_f32_32x32x16_bf16 v[112:127], v[164:167], v[172:175], v[112:127]
    s_add_u32 m0, s46, 45056
    s_nop 0
    buffer_load_dwordx4 v23, s[12:15], s41 offen lds
    s_waitcnt lgkmcnt(0)
    v_mfma_f32_32x32x16_bf16 v[64:79], v[128:131], v[136:139], v[64:79]
    s_waitcnt vmcnt(12)
    s_barrier
    ds_read_b64_tr_b16 v[160:161], v32 offset:0
    ds_read_b64_tr_b16 v[162:163], v32 offset:512
    ds_read_b64_tr_b16 v[164:165], v33 offset:0
    s_movk_i32 s41, 2432
    s_mov_b32 s45, 1245184
    s_add_u32 m0, s46, 49152
    s_nop 0
    buffer_load_dwordx4 v20, s[8:11], s45 offen lds
    v_mfma_f32_32x32x16_bf16 v[80:95], v[128:131], v[140:143], v[80:95]
    ds_read_b64_tr_b16 v[166:167], v33 offset:512
    ds_read_b128 v[168:171], v34 offset:0
    ds_read_b128 v[172:175], v35 offset:0
    s_add_u32 m0, s46, 53248
    s_nop 0
    buffer_load_dwordx4 v21, s[8:11], s45 offen lds
    v_mfma_f32_32x32x16_bf16 v[96:111], v[132:135], v[136:139], v[96:111]
    s_add_u32 m0, s46, 57344
    s_nop 0
    buffer_load_dwordx4 v22, s[12:15], s41 offen lds
    v_mfma_f32_32x32x16_bf16 v[112:127], v[132:135], v[140:143], v[112:127]
    s_add_u32 m0, s46, 61440
    s_nop 0
    buffer_load_dwordx4 v23, s[12:15], s41 offen lds
    s_waitcnt lgkmcnt(0)
    v_mfma_f32_32x32x16_bf16 v[64:79], v[160:163], v[168:171], v[64:79]
    s_waitcnt vmcnt(12)
    s_barrier
    ds_read_b64_tr_b16 v[128:129], v28 offset:0
    ds_read_b64_tr_b16 v[130:131], v28 offset:512
    ds_read_b64_tr_b16 v[132:133], v29 offset:0
    s_movk_i32 s41, 2688
    s_mov_b32 s45, 1376256
    s_add_u32 m0, s46, 65536
    s_nop 0
    buffer_load_dwordx4 v20, s[8:11], s45 offen lds
    v_mfma_f32_32x32x16_bf16 v[80:95], v[160:163], v[172:175], v[80:95]
    ds_read_b64_tr_b16 v[134:135], v29 offset:512
    ds_read_b128 v[136:139], v30 offset:0
    ds_read_b128 v[140:143], v31 offset:0
    s_add_u32 m0, s46, 69632
    s_nop 0
    buffer_load_dwordx4 v21, s[8:11], s45 offen lds
    v_mfma_f32_32x32x16_bf16 v[96:111], v[164:167], v[168:171], v[96:111]
    s_add_u32 m0, s46, 73728
    s_nop 0
    buffer_load_dwordx4 v22, s[12:15], s41 offen lds
    v_mfma_f32_32x32x16_bf16 v[112:127], v[164:167], v[172:175], v[112:127]
    s_add_u32 m0, s46, 77824
    s_nop 0
    buffer_load_dwordx4 v23, s[12:15], s41 offen lds
    s_waitcnt lgkmcnt(0)
    v_mfma_f32_32x32x16_bf16 v[64:79], v[128:131], v[136:139], v[64:79]
    s_waitcnt vmcnt(12)
    s_barrier
    ds_read_b64_tr_b16 v[160:161], v28 offset:16384
    ds_read_b64_tr_b16 v[162:163], v28 offset:16896
    ds_read_b64_tr_b16 v[164:165], v29 offset:16384
    s_movk_i32 s41, 2944
    s_mov_b32 s45, 1507328
    s_add_u32 m0, s46, 0
    s_nop 0
    buffer_load_dwordx4 v20, s[8:11], s45 offen lds
    v_mfma_f32_32x32x16_bf16 v[80:95], v[128:131], v[140:143], v[80:95]
    ds_read_b64_tr_b16 v[166:167], v29 offset:16896
    ds_read_b128 v[168:171], v30 offset:16384
    ds_read_b128 v[172:175], v31 offset:16384
    s_add_u32 m0, s46, 4096
    s_nop 0
    buffer_load_dwordx4 v21, s[8:11], s45 offen lds
    v_mfma_f32_32x32x16_bf16 v[96:111], v[132:135], v[136:139], v[96:111]
    s_add_u32 m0, s46, 8192
    s_nop 0
    buffer_load_dwordx4 v22, s[12:15], s41 offen lds
    v_mfma_f32_32x32x16_bf16 v[112:127], v[132:135], v[140:143], v[112:127]
    s_add_u32 m0, s46, 12288
    s_nop 0
    buffer_load_dwordx4 v23, s[12:15], s41 offen lds
    s_waitcnt lgkmcnt(0)
    v_mfma_f32_32x32x16_bf16 v[64:79], v[160:163], v[168:171], v[64:79]
    s_waitcnt vmcnt(12)
    s_barrier
    s_cmp_lg_u32 s3, 0
    s_cbranch_scc1 L_cw_57
    s_memrealtime s[56:57]
    s_waitcnt lgkmcnt(0)
    s_add_u32 s56, s56, 128
    s_addc_u32 s57, s57, 0
    v_cmp_ge_u64 vcc, v[250:251], s[70:71]
    v_cmp_lt_u64 s[56:57], v[250:251], s[56:57]
    s_and_b64 s[56:57], s[56:57], vcc
    s_cmp_eq_u64 s[56:57], -1
    s_cbranch_scc1 L_ok_59
L_spin_58:
    s_sleep 4
    buffer_load_dwordx2 v[250:251], v253, s[64:67], 0 offen sc0 sc1
    s_waitcnt vmcnt(0)
    s_memrealtime s[56:57]
    s_waitcnt lgkmcnt(0)
    s_add_u32 s56, s56, 128
    s_addc_u32 s57, s57, 0
    v_cmp_ge_u64 vcc, v[250:251], s[70:71]
    v_cmp_lt_u64 s[56:57], v[250:251], s[56:57]
    s_and_b64 s[56:57], s[56:57], vcc
    s_cmp_eq_u64 s[56:57], -1
    s_cbranch_scc0 L_spin_58
L_ok_59:
L_cw_57:
    ds_read_b64_tr_b16 v[128:129], v28 offset:32768
    ds_read_b64_tr_b16 v[130:131], v28 offset:33280
    ds_read_b64_tr_b16 v[132:133], v29 offset:32768
    s_movk_i32 s41, 3200
    s_mov_b32 s45, 1638400
    s_add_u32 m0, s46, 16384
    s_nop 0
    buffer_load_dwordx4 v20, s[8:11], s45 offen lds
    v_mfma_f32_32x32x16_bf16 v[80:95], v[160:163], v[172:175], v[80:95]
    ds_read_b64_tr_b16 v[134:135], v29 offset:33280
    ds_read_b128 v[136:139], v30 offset:32768
    ds_read_b128 v[140:143], v31 offset:32768
    s_add_u32 m0, s46, 20480
    s_nop 0
    buffer_load_dwordx4 v21, s[8:11], s45 offen lds
    v_mfma_f32_32x32x16_bf16 v[96:111], v[164:167], v[168:171], v[96:111]
    s_add_u32 m0, s46, 24576
    s_nop 0
    buffer_load_dwordx4 v22, s[12:15], s41 offen lds
    v_mfma_f32_32x32x16_bf16 v[112:127], v[164:167], v[172:175], v[112:127]
    s_add_u32 m0, s46, 28672
    s_nop 0
    buffer_load_dwordx4 v23, s[12:15], s41 offen lds
    s_waitcnt lgkmcnt(0)
    v_mfma_f32_32x32x16_bf16 v[64:79], v[128:131], v[136:139], v[64:79]
    s_waitcnt vmcnt(12)
    s_barrier
    ds_read_b64_tr_b16 v[160:161], v28 offset:49152
    ds_read_b64_tr_b16 v[162:163], v28 offset:49664
    ds_read_b64_tr_b16 v[164:165], v29 offset:49152
    s_movk_i32 s41, 3456
    s_mov_b32 s45, 1769472
    s_add_u32 m0, s46, 32768
    s_nop 0
    buffer_load_dwordx4 v20, s[8:11], s45 offen lds
    v_mfma_f32_32x32x16_bf16 v[80:95], v[128:131], v[140:143], v[80:95]
    ds_read_b64_tr_b16 v[166:167], v29 offset:49664
    ds_read_b128 v[168:171], v30 offset:49152
    ds_read_b128 v[172:175], v31 offset:49152
    s_add_u32 m0, s46, 36864
    s_nop 0
    buffer_load_dwordx4 v21, s[8:11], s45 offen lds
    v_mfma_f32_32x32x16_bf16 v[96:111], v[132:135], v[136:139], v[96:111]
    s_add_u32 m0, s46, 40960
    s_nop 0
    buffer_load_dwordx4 v22, s[12:15], s41 offen lds
    v_mfma_f32_32x32x16_bf16 v[112:127], v[132:135], v[140:143], v[112:127]
    s_add_u32 m0, s46, 45056
    s_nop 0
    buffer_load_dwordx4 v23, s[12:15], s41 offen lds
    s_lshr_b32 s40, s3, 1
    s_and_b32 s41, s3, 1
    s_lshl_b32 s42, s20, 6
    s_lshl_b32 s40, s40, 5
    s_add_u32 s42, s42, s40
    v_lshl_add_u32 v36, v15, 2, s42
    v_lshlrev_b32 v37, 1, v36
    s_lshl_b32 s43, s21, 6
    s_lshl_b32 s41, s41, 5
    s_add_u32 s43, s43, s41
    v_add_u32 v38, s43, v14
    v_lshl_add_u32 v39, v38, 10, v37
    v_lshlrev_b32 v40, 12, v36
    v_lshl_add_u32 v40, v38, 1, v40
    buffer_load_dwordx2 v[192:193], v37, s[24:27], 0 offen offset:0
    buffer_load_dwordx2 v[200:201], v39, s[32:35], 0 offen offset:0
    buffer_load_dwordx2 v[194:195], v37, s[24:27], 0 offen offset:16
    buffer_load_dwordx2 v[202:203], v39, s[32:35], 0 offen offset:16
    buffer_load_dwordx2 v[196:197], v37, s[24:27], 0 offen offset:32
    buffer_load_dwordx2 v[204:205], v39, s[32:35], 0 offen offset:32
    buffer_load_dwordx2 v[198:199], v37, s[24:27], 0 offen offset:48
    buffer_load_dwordx2 v[206:207], v39, s[32:35], 0 offen offset:48
    s_mov_b32 s44, 0
    buffer_load_ushort v208, v40, s[16:19], s44 offen
    s_mov_b32 s44, 4096
    buffer_load_ushort v209, v40, s[16:19], s44 offen
    s_mov_b32 s44, 8192
    buffer_load_ushort v210, v40, s[16:19], s44 offen
    s_mov_b32 s44, 12288
    buffer_load_ushort v211, v40, s[16:19], s44 offen
    s_mov_b32 s44, 32768
    buffer_load_ushort v212, v40, s[16:19], s44 offen
    s_mov_b32 s44, 36864
    buffer_load_ushort v213, v40, s[16:19], s44 offen
    s_mov_b32 s44, 40960
    buffer_load_ushort v214, v40, s[16:19], s44 offen
    s_mov_b32 s44, 45056
    buffer_load_ushort v215, v40, s[16:19], s44 offen
    s_mov_b32 s44, 65536
    buffer_load_ushort v216, v40, s[16:19], s44 offen
    s_mov_b32 s44, 69632
    buffer_load_ushort v217, v40, s[16:19], s44 offen
    s_mov_b32 s44, 73728
    buffer_load_ushort v218, v40, s[16:19], s44 offen
    s_mov_b32 s44, 77824
    buffer_load_ushort v219, v40, s[16:19], s44 offen
    s_mov_b32 s44, 98304
    buffer_load_ushort v220, v40, s[16:19], s44 offen
    s_mov_b32 s44, 102400
    buffer_load_ushort v221, v40, s[16:19], s44 offen
    s_mov_b32 s44, 106496
    buffer_load_ushort v222, v40, s[16:19], s44 offen
    s_mov_b32 s44, 110592
    buffer_load_ushort v223, v40, s[16:19], s44 offen
    v_lshlrev_b32 v3, 4, v12
    s_xor_b32 s40, s3, 0
    s_and_b32 s41, s40, 1
    s_mul_i32 s41, s41, 12288
    s_lshr_b32 s40, s40, 1
    s_mul_i32 s40, s40, 49152
    s_add_u32 s40, s40, s41
    v_add_u32 v51, s40, v3
    s_xor_b32 s40, s3, 1
    s_and_b32 s41, s40, 1
    s_mul_i32 s41, s41, 12288
    s_lshr_b32 s40, s40, 1
    s_mul_i32 s40, s40, 49152
    s_add_u32 s40, s40, s41
    v_add_u32 v48, s40, v3
    s_xor_b32 s40, s3, 2
    s_and_b32 s41, s40, 1
    s_mul_i32 s41, s41, 12288
    s_lshr_b32 s40, s40, 1
    s_mul_i32 s40, s40, 49152
    s_add_u32 s40, s40, s41
    v_add_u32 v49, s40, v3
    s_xor_b32 s40, s3, 3
    s_and_b32 s41, s40, 1
    s_mul_i32 s41, s41, 12288
    s_lshr_b32 s40, s40, 1
    s_mul_i32 s40, s40, 49152
    s_add_u32 s40, s40, s41
    v_add_u32 v50, s40, v3
    s_and_b32 s40, s3, 1
    s_lshr_b32 s41, s3, 1
    s_mul_i32 s40, s40, 4608
    s_lshl_b32 s41, s41, 6
    s_add_u32 s40, s40, s41
    s_movk_i32 s42, 144
    v_mul_lo_u32 v44, v14, s42
    v_lshl_add_u32 v44, v15, 3, v44
    v_add_u32 v44, s40, v44
    v_lshrrev_b32 v5, 3, v12
    v_lshl_add_u32 v5, v13, 4, v5
    v_and_b32 v6, 7, v12
    v_mul_lo_u32 v45, v5, s42
    v_lshl_add_u32 v45, v6, 4, v45
    s_lshl_b32 s43, s21, 16
    s_lshl_b32 s42, s20, 7
    s_add_u32 s43, s43, s42
    v_lshlrev_b32 v46, 10, v5
    v_lshl_add_u32 v46, v6, 4, v46
    v_add_u32 v46, s43, v46
    v_add_u32 v47, 8192, v46
    s_waitcnt lgkmcnt(0)
    v_mfma_f32_32x32x16_bf16 v[64:79], v[160:163], v[168:171], v[64:79]
    s_waitcnt vmcnt(36)
    s_barrier
    ds_read_b64_tr_b16 v[128:129], v32 offset:0
    ds_read_b64_tr_b16 v[130:131], v32 offset:512
    ds_read_b64_tr_b16 v[132:133], v33 offset:0
    v_mfma_f32_32x32x16_bf16 v[80:95], v[160:163], v[172:175], v[80:95]
    ds_read_b64_tr_b16 v[134:135], v33 offset:512
    ds_read_b128 v[136:139], v34 offset:0
    ds_read_b128 v[140:143], v35 offset:0
    v_mfma_f32_32x32x16_bf16 v[96:111], v[164:167], v[168:171], v[96:111]
    v_mfma_f32_32x32x16_bf16 v[112:127], v[164:167], v[172:175], v[112:127]
    s_waitcnt lgkmcnt(0)
    v_mfma_f32_32x32x16_bf16 v[64:79], v[128:131], v[136:139], v[64:79]
    s_waitcnt vmcnt(32)
    s_barrier
    ds_read_b64_tr_b16 v[160:161], v28 offset:0
    ds_read_b64_tr_b16 v[162:163], v28 offset:512
    ds_read_b64_tr_b16 v[164:165], v29 offset:0
    v_mfma_f32_32x32x16_bf16 v[80:95], v[128:131], v[140:143], v[80:95]
    ds_read_b64_tr_b16 v[166:167], v29 offset:512
    ds_read_b128 v[168:171], v30 offset:0
    ds_read_b128 v[172:175], v31 offset:0
    v_mfma_f32_32x32x16_bf16 v[96:111], v[132:135], v[136:139], v[96:111]
    v_mfma_f32_32x32x16_bf16 v[112:127], v[132:135], v[140:143], v[112:127]
    s_waitcnt lgkmcnt(0)
    v_mfma_f32_32x32x16_bf16 v[64:79], v[160:163], v[168:171], v[64:79]
    s_waitcnt vmcnt(28)
    s_barrier
    ds_read_b64_tr_b16 v[128:129], v28 offset:16384
    ds_read_b64_tr_b16 v[130:131], v28 offset:16896
    ds_read_b64_tr_b16 v[132:133], v29 offset:16384
    v_mfma_f32_32x32x16_bf16 v[80:95], v[160:163], v[172:175], v[80:95]
    ds_read_b64_tr_b16 v[134:135], v29 offset:16896
    ds_read_b128 v[136:139], v30 offset:16384
    ds_read_b128 v[140:143], v31 offset:16384
    v_mfma_f32_32x32x16_bf16 v[96:111], v[164:167], v[168:171], v[96:111]
    v_mfma_f32_32x32x16_bf16 v[112:127], v[164:167], v[172:175], v[112:127]
    s_waitcnt lgkmcnt(0)
    v_mfma_f32_32x32x16_bf16 v[64:79], v[128:131], v[136:139], v[64:79]
    s_waitcnt vmcnt(24)
    s_barrier
    ds_read_b64_tr_b16 v[160:161], v28 offset:32768
    ds_read_b64_tr_b16 v[162:163], v28 offset:33280
    ds_read_b64_tr_b16 v[164:165], v29 offset:32768
    v_mfma_f32_32x32x16_bf16 v[80:95], v[128:131], v[140:143], v[80:95]
    ds_read_b64_tr_b16 v[166:167], v29 offset:33280
    ds_read_b128 v[168:171], v30 offset:32768
    ds_read_b128 v[172:175], v31 offset:32768
    v_mfma_f32_32x32x16_bf16 v[96:111], v[132:135], v[136:139], v[96:111]
    v_mfma_f32_32x32x16_bf16 v[112:127], v[132:135], v[140:143], v[112:127]
    s_waitcnt lgkmcnt(0)
    v_mfma_f32_32x32x16_bf16 v[64:79], v[160:163], v[168:171], v[64:79]
    v_mfma_f32_32x32x16_bf16 v[80:95], v[160:163], v[172:175], v[80:95]
    v_mfma_f32_32x32x16_bf16 v[96:111], v[164:167], v[168:171], v[96:111]
    v_mfma_f32_32x32x16_bf16 v[112:127], v[164:167], v[172:175], v[112:127]
    s_nop 15
    s_nop 3
    ds_write_b128 v48, v[80:83] offset:0
    ds_write_b128 v48, v[84:87] offset:1024
    ds_write_b128 v48, v[88:91] offset:2048
    ds_write_b128 v48, v[92:95] offset:3072
    ds_write_b128 v49, v[96:99] offset:4096
    ds_write_b128 v49, v[100:103] offset:5120
    ds_write_b128 v49, v[104:107] offset:6144
    ds_write_b128 v49, v[108:111] offset:7168
    ds_write_b128 v50, v[112:115] offset:8192
    ds_write_b128 v50, v[116:119] offset:9216
    ds_write_b128 v50, v[120:123] offset:10240
    ds_write_b128 v50, v[124:127] offset:11264
    s_waitcnt lgkmcnt(0)
    s_barrier
    ds_read_b128 v[80:83], v51 offset:0
    ds_read_b128 v[96:99], v51 offset:4096
    ds_read_b128 v[112:115], v51 offset:8192
    ds_read_b128 v[84:87], v51 offset:1024
    ds_read_b128 v[100:103], v51 offset:5120
    ds_read_b128 v[116:119], v51 offset:9216
    ds_read_b128 v[88:91], v51 offset:2048
    ds_read_b128 v[104:107], v51 offset:6144
    ds_read_b128 v[120:123], v51 offset:10240
    ds_read_b128 v[92:95], v51 offset:3072
    ds_read_b128 v[108:111], v51 offset:7168
    ds_read_b128 v[124:127], v51 offset:11264
    s_waitcnt vmcnt(0)
    v_lshlrev_b32 v160, 16, v200
    v_and_b32 v161, 0xffff0000, v200
    v_lshlrev_b32 v208, 16, v208
    v_lshlrev_b32 v209, 16, v209
    v_lshlrev_b32 v128, 16, v192
    v_pk_add_f32 v[144:145], v[208:209], v[160:161]
    v_and_b32 v129, 0xffff0000, v192
    v_cvt_pk_bf16_f32 v162, v144, v145
    v_lshlrev_b32 v144, 16, v162
    v_and_b32 v145, 0xffff0000, v162
    v_lshlrev_b32 v164, 16, v201
    v_and_b32 v165, 0xffff0000, v201
    v_lshlrev_b32 v210, 16, v210
    v_lshlrev_b32 v211, 16, v211
    v_lshlrev_b32 v130, 16, v193
    v_pk_add_f32 v[146:147], v[210:211], v[164:165]
    v_and_b32 v131, 0xffff0000, v193
    v_cvt_pk_bf16_f32 v166, v146, v147
    v_lshlrev_b32 v146, 16, v166
    v_and_b32 v147, 0xffff0000, v166
    v_lshlrev_b32 v160, 16, v202
    v_and_b32 v161, 0xffff0000, v202
    v_lshlrev_b32 v212, 16, v212
    v_lshlrev_b32 v213, 16, v213
    v_lshlrev_b32 v132, 16, v194
    v_pk_add_f32 v[148:149], v[212:213], v[160:161]
    v_and_b32 v133, 0xffff0000, v194
    v_cvt_pk_bf16_f32 v162, v148, v149
    v_lshlrev_b32 v148, 16, v162
    v_and_b32 v149, 0xffff0000, v162
    v_lshlrev_b32 v164, 16, v203
    v_and_b32 v165, 0xffff0000, v203
    v_lshlrev_b32 v214, 16, v214
    v_lshlrev_b32 v215, 16, v215
    v_lshlrev_b32 v134, 16, v195
    v_pk_add_f32 v[150:151], v[214:215], v[164:165]
    v_and_b32 v135, 0xffff0000, v195
    v_cvt_pk_bf16_f32 v166, v150, v151
    v_lshlrev_b32 v150, 16, v166
    v_and_b32 v151, 0xffff0000, v166
    v_lshlrev_b32 v160, 16, v204
    v_and_b32 v161, 0xffff0000, v204
    v_lshlrev_b32 v216, 16, v216
    v_lshlrev_b32 v217, 16, v217
    v_lshlrev_b32 v136, 16, v196
    v_pk_add_f32 v[152:153], v[216:217], v[160:161]
    v_and_b32 v137, 0xffff0000, v196
    v_cvt_pk_bf16_f32 v162, v152, v153
    v_lshlrev_b32 v152, 16, v162
    v_and_b32 v153, 0xffff0000, v162
    v_lshlrev_b32 v164, 16, v205
    v_and_b32 v165, 0xffff0000, v205
    v_lshlrev_b32 v218, 16, v218
    v_lshlrev_b32 v219, 16, v219
    v_lshlrev_b32 v138, 16, v197
    v_pk_add_f32 v[154:155], v[218:219], v[164:165]
    v_and_b32 v139, 0xffff0000, v197
    v_cvt_pk_bf16_f32 v166, v154, v155
    v_lshlrev_b32 v154, 16, v166
    v_and_b32 v155, 0xffff0000, v166
    v_lshlrev_b32 v160, 16, v206
    v_and_b32 v161, 0xffff0000, v206
    v_lshlrev_b32 v220, 16, v220
    v_lshlrev_b32 v221, 16, v221
    v_lshlrev_b32 v140, 16, v198
    v_pk_add_f32 v[156:157], v[220:221], v[160:161]
    v_and_b32 v141, 0xffff0000, v198
    v_cvt_pk_bf16_f32 v162, v156, v157
    v_lshlrev_b32 v156, 16, v162
    v_and_b32 v157, 0xffff0000, v162
    v_lshlrev_b32 v164, 16, v207
    v_and_b32 v165, 0xffff0000, v207
    v_lshlrev_b32 v222, 16, v222
    v_lshlrev_b32 v223, 16, v223
    v_lshlrev_b32 v142, 16, v199
    v_pk_add_f32 v[158:159], v[222:223], v[164:165]
    v_and_b32 v143, 0xffff0000, v199
    v_cvt_pk_bf16_f32 v166, v158, v159
    v_lshlrev_b32 v158, 16, v166
    v_and_b32 v159, 0xffff0000, v166
    s_waitcnt lgkmcnt(9)
    v_pk_add_f32 v[64:65], v[64:65], v[80:81]
    v_pk_add_f32 v[66:67], v[66:67], v[82:83]
    v_pk_add_f32 v[64:65], v[64:65], v[96:97]
    v_pk_add_f32 v[66:67], v[66:67], v[98:99]
    v_pk_add_f32 v[64:65], v[64:65], v[112:113]
    v_pk_add_f32 v[66:67], v[66:67], v[114:115]
    v_cvt_pk_bf16_f32 v160, v64, v65
    v_cvt_pk_bf16_f32 v161, v66, v67
    v_lshlrev_b32 v64, 16, v160
    v_and_b32 v65, 0xffff0000, v160
    v_lshlrev_b32 v66, 16, v161
    v_and_b32 v67, 0xffff0000, v161
    v_pk_add_f32 v[64:65], v[64:65], v[128:129]
    v_pk_add_f32 v[66:67], v[66:67], v[130:131]
    v_cvt_pk_bf16_f32 v160, v64, v65
    v_cvt_pk_bf16_f32 v161, v66, v67
    v_lshlrev_b32 v64, 16, v160
    v_and_b32 v65, 0xffff0000, v160
    v_lshlrev_b32 v66, 16, v161
    v_and_b32 v67, 0xffff0000, v161
    v_pk_add_f32 v[64:65], v[64:65], v[144:145]
    v_pk_add_f32 v[66:67], v[66:67], v[146:147]
    v_cvt_pk_bf16_f32 v176, v64, v65
    v_cvt_pk_bf16_f32 v177, v66, v67
    ds_write_b64 v44, v[176:177] offset:32768
    s_waitcnt lgkmcnt(7)
    v_pk_add_f32 v[68:69], v[68:69], v[84:85]
    v_pk_add_f32 v[70:71], v[70:71], v[86:87]
    v_pk_add_f32 v[68:69], v[68:69], v[100:101]
    v_pk_add_f32 v[70:71], v[70:71], v[102:103]
    v_pk_add_f32 v[68:69], v[68:69], v[116:117]
    v_pk_add_f32 v[70:71], v[70:71], v[118:119]
    v_cvt_pk_bf16_f32 v160, v68, v69
    v_cvt_pk_bf16_f32 v161, v70, v71
    v_lshlrev_b32 v68, 16, v160
    v_and_b32 v69, 0xffff0000, v160
    v_lshlrev_b32 v70, 16, v161
    v_and_b32 v71, 0xffff0000, v161
    v_pk_add_f32 v[68:69], v[68:69], v[132:133]
    v_pk_add_f32 v[70:71], v[70:71], v[134:135]
    v_cvt_pk_bf16_f32 v160, v68, v69
    v_cvt_pk_bf16_f32 v161, v70, v71
    v_lshlrev_b32 v68, 16, v160
    v_and_b32 v69, 0xffff0000, v160
    v_lshlrev_b32 v70, 16, v161
    v_and_b32 v71, 0xffff0000, v161
    v_pk_add_f32 v[68:69], v[68:69], v[148:149]
    v_pk_add_f32 v[70:71], v[70:71], v[150:151]
    v_cvt_pk_bf16_f32 v178, v68, v69
    v_cvt_pk_bf16_f32 v179, v70, v71
    ds_write_b64 v44, v[178:179] offset:32784
    s_waitcnt lgkmcnt(5)
    v_pk_add_f32 v[72:73], v[72:73], v[88:89]
    v_pk_add_f32 v[74:75], v[74:75], v[90:91]
    v_pk_add_f32 v[72:73], v[72:73], v[104:105]
    v_pk_add_f32 v[74:75], v[74:75], v[106:107]
    v_pk_add_f32 v[72:73], v[72:73], v[120:121]
    v_pk_add_f32 v[74:75], v[74:75], v[122:123]
    v_cvt_pk_bf16_f32 v160, v72, v73
    v_cvt_pk_bf16_f32 v161, v74, v75
    v_lshlrev_b32 v72, 16, v160
    v_and_b32 v73, 0xffff0000, v160
    v_lshlrev_b32 v74, 16, v161
    v_and_b32 v75, 0xffff0000, v161
    v_pk_add_f32 v[72:73], v[72:73], v[136:137]
    v_pk_add_f32 v[74:75], v[74:75], v[138:139]
    v_cvt_pk_bf16_f32 v160, v72, v73
    v_cvt_pk_bf16_f32 v161, v74, v75
    v_lshlrev_b32 v72, 16, v160
    v_and_b32 v73, 0xffff0000, v160
    v_lshlrev_b32 v74, 16, v161
    v_and_b32 v75, 0xffff0000, v161
    v_pk_add_f32 v[72:73], v[72:73], v[152:153]
    v_pk_add_f32 v[74:75], v[74:75], v[154:155]
    v_cvt_pk_bf16_f32 v180, v72, v73
    v_cvt_pk_bf16_f32 v181, v74, v75
    ds_write_b64 v44, v[180:181] offset:32800
    s_waitcnt lgkmcnt(3)
    v_pk_add_f32 v[76:77], v[76:77], v[92:93]
    v_pk_add_f32 v[78:79], v[78:79], v[94:95]
    v_pk_add_f32 v[76:77], v[76:77], v[108:109]
    v_pk_add_f32 v[78:79], v[78:79], v[110:111]
    v_pk_add_f32 v[76:77], v[76:77], v[124:125]
    v_pk_add_f32 v[78:79], v[78:79], v[126:127]
    v_cvt_pk_bf16_f32 v160, v76, v77
    v_cvt_pk_bf16_f32 v161, v78, v79
    v_lshlrev_b32 v76, 16, v160
    v_and_b32 v77, 0xffff0000, v160
    v_lshlrev_b32 v78, 16, v161
    v_and_b32 v79, 0xffff0000, v161
    v_pk_add_f32 v[76:77], v[76:77], v[140:141]
    v_pk_add_f32 v[78:79], v[78:79], v[142:143]
    v_cvt_pk_bf16_f32 v160, v76, v77
    v_cvt_pk_bf16_f32 v161, v78, v79
    v_lshlrev_b32 v76, 16, v160
    v_and_b32 v77, 0xffff0000, v160
    v_lshlrev_b32 v78, 16, v161
    v_and_b32 v79, 0xffff0000, v161
    v_pk_add_f32 v[76:77], v[76:77], v[156:157]
    v_pk_add_f32 v[78:79], v[78:79], v[158:159]
    v_cvt_pk_bf16_f32 v182, v76, v77
    v_cvt_pk_bf16_f32 v183, v78, v79
    ds_write_b64 v44, v[182:183] offset:32816
    s_waitcnt lgkmcnt(0)
    s_barrier
    ds_read_b128 v[64:67], v45 offset:32768
    ds_read_b128 v[68:71], v45 offset:33920
    s_waitcnt lgkmcnt(1)
    buffer_store_dwordx4 v[64:67], v46, s[36:39], 0 offen sc0 sc1
    s_waitcnt lgkmcnt(0)
    buffer_store_dwordx4 v[68:71], v47, s[36:39], 0 offen sc0 sc1
L_end_fin:
    s_endpgm
.section .rodata,"a"
.p2align 6
.amdhsa_kernel mid_kernel
  .amdhsa_next_free_vgpr 256
  .amdhsa_next_free_sgpr 102
  .amdhsa_accum_offset 256
  .amdhsa_group_segment_fixed_size 0
  .amdhsa_kernarg_size 120
  .amdhsa_user_sgpr_count 2
  .amdhsa_user_sgpr_kernarg_segment_ptr 1
  .amdhsa_system_sgpr_workgroup_id_x 1
.end_amdhsa_kernel
```
